```python
import torch

def _softmax(x, axis=-1):
    return torch.softmax(x, dim=axis)
def _gelu(x):
    return torch.nn.functional.gelu(x, approximate="tanh")
def _silu(x):
    return torch.nn.functional.silu(x)
def _sigmoid(x):
    return torch.sigmoid(x)
def _layernorm(x, axis=-1, eps=1e-5):
    m = x.mean(dim=axis, keepdim=True)
    v = x.var(dim=axis, keepdim=True, unbiased=False)
    return (x - m) / torch.sqrt(v + eps)
def _scatter_add(tgt, idx, src, axis=0):
    return tgt.clone().index_add_(axis, idx, src)
def _segment_sum(src, seg, n):
    out = torch.zeros((n,) + src.shape[1:], dtype=src.dtype)
    return out.index_add_(0, seg, src)
def _pad(x, pw):
    flat = tuple(v for pair in reversed(pw) for v in pair)
    return torch.nn.functional.pad(x, flat)

kernel_name = 'sequential_preLN__mha_block_cached__dense_activation_squared_relu__decode'

def setup_inputs():

    _w = (lambda a: (lambda t: t.to(torch.bfloat16) if t.is_floating_point() else t)(torch.as_tensor(a)))
    def _A_setup():
        B, Sq, D = 1, 1, 448
        H, Sk, Dh = 16, 32768, 256
        return {
            "x": _w((lambda *s: torch.randn(*s, dtype=torch.bfloat16) * 0.05)(B, Sq, D)),
            "k_cache": _w((lambda *s: torch.randn(*s, dtype=torch.bfloat16) * 3.2)(B, H, Sk, Dh)),
            "v_cache": _w((lambda *s: torch.randn(*s, dtype=torch.bfloat16) * 0.4)(B, H, Sk, Dh)),
            "wq": _w((lambda *s: torch.randn(*s, dtype=torch.bfloat16) * 3.2)(D, H * Dh) * (D ** -0.5)),
            "wo": _w((lambda *s: torch.randn(*s, dtype=torch.bfloat16) * 0.4)(H * Dh, D) * ((H * Dh) ** -0.5)),
        }
    _A_in = _A_setup()

    def _B_setup():
        B, S, D, F = 1, 1, 448, 1792
        return {
            "x": _w((lambda *s: torch.randn(*s, dtype=torch.bfloat16) * 0.05)(B, S, D)),
            "w1": _w((lambda *s: torch.randn(*s, dtype=torch.bfloat16) * 0.05)(D, F)),
            "b1": _w((lambda *s: torch.randn(*s, dtype=torch.bfloat16) * 0.8)(F)),
            "w2": _w((lambda *s: torch.randn(*s, dtype=torch.bfloat16) * 0.05)(F, D)),
            "b2": _w((lambda *s: torch.randn(*s, dtype=torch.bfloat16) * 3.2)(D)),
        }
    _B_in = _B_setup()

    return {
        "A_x": _A_in["x"],
        "A_k_cache": _A_in["k_cache"],
        "A_v_cache": _A_in["v_cache"],
        "A_wq": _A_in["wq"],
        "A_wo": _A_in["wo"],
        "B_x": _B_in["x"],
        "B_w1": _B_in["w1"],
        "B_b1": _B_in["b1"],
        "B_w2": _B_in["w2"],
        "B_b2": _B_in["b2"],
    }

def reference(A_x, A_k_cache, A_v_cache, A_wq, A_wo, B_x, B_w1, B_b1, B_w2, B_b2):
    def _A_ref(x, k_cache, v_cache, wq, wo):
        B, Sq, D = x.shape
        H, Dh = 16, 256
        q = (lambda x, *d: x.permute(*d))((x @ wq).reshape(B, Sq, H, Dh), 0, 2, 1, 3)
        scores = torch.einsum("bhqd,bhkd->bhqk", q, k_cache) * (Dh ** -0.5)
        p = _softmax(scores, axis=-1)
        o = torch.einsum("bhqk,bhkd->bhqd", p, v_cache)
        return (lambda x, *d: x.permute(*d))(o, 0, 2, 1, 3).reshape(B, Sq, H * Dh) @ wo

    def _B_ref(x, w1, b1, w2, b2):
        h = torch.einsum("bsd,df->bsf", x, w1) + b1
        zero = torch.zeros_like(h)
        r = torch.where(h > zero, h, zero)
        h = r * r
        out = torch.einsum("bsf,fd->bsd", h, w2) + b2
        return out

    x = A_x
    h = x + _A_ref(_layernorm(x, axis=-1), A_k_cache, A_v_cache, A_wq, A_wo)
    h2 = h + _B_ref(_layernorm(h, axis=-1), B_w1, B_b1, B_w2, B_b2)
    return h2
```

```asm
; @launch grid=(256,1,1) block=(512,1,1) lds=71680
.amdgcn_target "amdgcn-amd-amdhsa--gfx950"
.text
.globl sequential_preLN__mha_block_cached__dense_activation_squared_relu__decode_kernel
.p2align 8
.type sequential_preLN__mha_block_cached__dense_activation_squared_relu__decode_kernel,@function
sequential_preLN__mha_block_cached__dense_activation_squared_relu__decode_kernel:
    s_cmp_ge_u32 s2, 256
    s_cbranch_scc1 L_end
    s_load_dwordx16 s[4:19], s[0:1], 0
    s_load_dwordx8 s[20:27], s[0:1], 64
    s_load_dwordx2 s[28:29], s[0:1], 96
    v_and_b32 v1, 63, v0
    v_lshrrev_b32 v4, 6, v0
    s_add_u32 s30, s2, 0
    s_and_b32 s30, s30, 7
    v_readfirstlane_b32 s52, v4
    s_lshl_b32 s30, s30, 1
    s_bfe_u32 s54, s2, 0x10003
    s_or_b32 s30, s30, s54
    s_lshr_b32 s31, s2, 4
    v_and_b32 v10, 31, v1
    v_lshrrev_b32 v11, 5, v1
    s_waitcnt lgkmcnt(0)
    s_cmp_ge_u32 s52, 4
    s_cbranch_scc1 L_helper
    s_lshl_b32 s54, s30, 24
    s_lshl_b32 s53, s31, 20
    s_or_b32 s54, s54, s53
    s_add_u32 s32, s6, s54
    s_addc_u32 s33, s7, 0
    s_mov_b32 s34, 0x100000
    s_mov_b32 s35, 0x20000
    s_add_u32 s36, s8, s54
    s_addc_u32 s37, s9, 0
    s_mov_b32 s38, 0x100000
    s_mov_b32 s39, 0x20000
    s_mul_i32 s54, s52, 1024
    v_lshlrev_b32 v2, 4, v1
    v_add_u32 v2, s54, v2
    s_mov_b32 s53, 0
    buffer_load_dwordx4 v[112:115], v2, s[32:35], s53 offen offset:0 nt
    s_add_u32 s54, s53, 4096
    buffer_load_dwordx4 v[116:119], v2, s[32:35], s54 offen offset:0 nt
    s_add_u32 s54, s53, 8192
    buffer_load_dwordx4 v[120:123], v2, s[32:35], s54 offen offset:0 nt
    s_add_u32 s54, s53, 12288
    buffer_load_dwordx4 v[124:127], v2, s[32:35], s54 offen offset:0 nt
    s_add_u32 s54, s53, 16384
    buffer_load_dwordx4 v[128:131], v2, s[32:35], s54 offen offset:0 nt
    s_waitcnt vmcnt(4)
    s_add_u32 s54, s53, 20480
    buffer_load_dwordx4 v[132:135], v2, s[32:35], s54 offen offset:0 nt
    s_waitcnt vmcnt(4)
    s_add_u32 s54, s53, 24576
    buffer_load_dwordx4 v[136:139], v2, s[32:35], s54 offen offset:0 nt
    s_waitcnt vmcnt(4)
    s_add_u32 s54, s53, 28672
    buffer_load_dwordx4 v[140:143], v2, s[32:35], s54 offen offset:0 nt
    s_waitcnt vmcnt(4)
    s_add_u32 s54, s53, 32768
    buffer_load_dwordx4 v[144:147], v2, s[32:35], s54 offen offset:0 nt
    s_waitcnt vmcnt(4)
    s_add_u32 s54, s53, 36864
    buffer_load_dwordx4 v[148:151], v2, s[32:35], s54 offen offset:0 nt
    s_waitcnt vmcnt(4)
    s_add_u32 s54, s53, 40960
    buffer_load_dwordx4 v[152:155], v2, s[32:35], s54 offen offset:0 nt
    s_waitcnt vmcnt(4)
    s_add_u32 s54, s53, 45056
    buffer_load_dwordx4 v[156:159], v2, s[32:35], s54 offen offset:0 nt
    s_waitcnt vmcnt(4)
    s_add_u32 s54, s53, 49152
    buffer_load_dwordx4 v[160:163], v2, s[32:35], s54 offen offset:0 nt
    s_waitcnt vmcnt(4)
    s_add_u32 s54, s53, 53248
    buffer_load_dwordx4 v[164:167], v2, s[32:35], s54 offen offset:0 nt
    s_waitcnt vmcnt(4)
    s_add_u32 s54, s53, 57344
    buffer_load_dwordx4 v[168:171], v2, s[32:35], s54 offen offset:0 nt
    s_waitcnt vmcnt(4)
    s_add_u32 s54, s53, 61440
    buffer_load_dwordx4 v[172:175], v2, s[32:35], s54 offen offset:0 nt
    s_waitcnt vmcnt(4)
    s_add_u32 s54, s53, 65536
    buffer_load_dwordx4 v[176:179], v2, s[32:35], s54 offen offset:0 nt
    s_waitcnt vmcnt(4)
    s_add_u32 s54, s53, 69632
    buffer_load_dwordx4 v[180:183], v2, s[32:35], s54 offen offset:0 nt
    s_waitcnt vmcnt(4)
    s_add_u32 s54, s53, 73728
    buffer_load_dwordx4 v[184:187], v2, s[32:35], s54 offen offset:0 nt
    s_waitcnt vmcnt(4)
    s_add_u32 s54, s53, 77824
    buffer_load_dwordx4 v[188:191], v2, s[32:35], s54 offen offset:0 nt
    s_waitcnt vmcnt(4)
    s_add_u32 s54, s53, 81920
    buffer_load_dwordx4 v[192:195], v2, s[32:35], s54 offen offset:0 nt
    s_waitcnt vmcnt(4)
    s_add_u32 s54, s53, 86016
    buffer_load_dwordx4 v[196:199], v2, s[32:35], s54 offen offset:0 nt
    s_waitcnt vmcnt(4)
    s_add_u32 s54, s53, 90112
    buffer_load_dwordx4 v[200:203], v2, s[32:35], s54 offen offset:0 nt
    s_waitcnt vmcnt(4)
    s_add_u32 s54, s53, 94208
    buffer_load_dwordx4 v[204:207], v2, s[32:35], s54 offen offset:0 nt
    s_waitcnt vmcnt(4)
    s_add_u32 s54, s53, 98304
    buffer_load_dwordx4 v[208:211], v2, s[32:35], s54 offen offset:0 nt
    s_waitcnt vmcnt(4)
    s_add_u32 s54, s53, 102400
    buffer_load_dwordx4 v[212:215], v2, s[32:35], s54 offen offset:0 nt
    s_waitcnt vmcnt(4)
    s_add_u32 s54, s53, 106496
    buffer_load_dwordx4 v[216:219], v2, s[32:35], s54 offen offset:0 nt
    s_waitcnt vmcnt(4)
    s_add_u32 s54, s53, 110592
    buffer_load_dwordx4 v[220:223], v2, s[32:35], s54 offen offset:0 nt
    s_waitcnt vmcnt(4)
    s_add_u32 s54, s53, 114688
    buffer_load_dwordx4 v[224:227], v2, s[32:35], s54 offen offset:0 nt
    s_waitcnt vmcnt(4)
    s_add_u32 s54, s53, 118784
    buffer_load_dwordx4 v[228:231], v2, s[32:35], s54 offen offset:0 nt
    s_waitcnt vmcnt(4)
    s_add_u32 s54, s53, 122880
    buffer_load_dwordx4 v[232:235], v2, s[32:35], s54 offen offset:0 nt
    s_waitcnt vmcnt(4)
    s_add_u32 s54, s53, 126976
    buffer_load_dwordx4 v[236:239], v2, s[32:35], s54 offen offset:0 nt
    s_mov_b32 s56, 0xcccccccc
    s_mov_b32 s57, 0xcccccccc
    s_mov_b32 s58, 0xaaaaaaaa
    s_mov_b32 s59, 0xaaaaaaaa
    v_lshlrev_b32 v9, 10, v11
    s_lshl_b32 s54, s52, 11
    v_add_u32 v9, s54, v9
    v_bfrev_b32 v4, v10
    v_lshrrev_b32 v4, 27, v4
    v_lshl_add_u32 v8, v4, 2, v9
    v_lshlrev_b32 v4, 4, v10
    s_barrier
    ds_read_b128 v[12:15], v4 offset:2048
    s_waitcnt lgkmcnt(0)
    s_mov_b32 s55, 0
L_kloop:
    s_add_u32 s53, s53, 131072
    s_cmp_eq_u32 s55, 7
    s_cselect_b32 s32, s36, s32
    s_cselect_b32 s33, s37, s33
    s_cselect_b32 s53, 0, s53
    v_mov_b32 v32, 0
    s_waitcnt vmcnt(4)
    v_dot2c_f32_bf16 v32, v112, v12
    v_dot2c_f32_bf16 v32, v113, v13
    v_dot2c_f32_bf16 v32, v114, v14
    v_dot2c_f32_bf16 v32, v115, v15
    buffer_load_dwordx4 v[112:115], v2, s[32:35], s53 offen offset:0 nt
    v_mov_b32 v33, 0
    s_waitcnt vmcnt(4)
    v_dot2c_f32_bf16 v33, v116, v12
    v_dot2c_f32_bf16 v33, v117, v13
    v_dot2c_f32_bf16 v33, v118, v14
    v_dot2c_f32_bf16 v33, v119, v15
    s_add_u32 s54, s53, 4096
    buffer_load_dwordx4 v[116:119], v2, s[32:35], s54 offen offset:0 nt
    s_nop 2
    v_permlane16_swap_b32 v32, v33
    v_add_f32 v32, v32, v33
    v_mov_b32 v34, 0
    s_waitcnt vmcnt(4)
    v_dot2c_f32_bf16 v34, v120, v12
    v_dot2c_f32_bf16 v34, v121, v13
    v_dot2c_f32_bf16 v34, v122, v14
    v_dot2c_f32_bf16 v34, v123, v15
    s_add_u32 s54, s53, 8192
    buffer_load_dwordx4 v[120:123], v2, s[32:35], s54 offen offset:0 nt
    v_mov_b32 v35, 0
    s_waitcnt vmcnt(4)
    v_dot2c_f32_bf16 v35, v124, v12
    v_dot2c_f32_bf16 v35, v125, v13
    v_dot2c_f32_bf16 v35, v126, v14
    v_dot2c_f32_bf16 v35, v127, v15
    s_add_u32 s54, s53, 12288
    buffer_load_dwordx4 v[124:127], v2, s[32:35], s54 offen offset:0 nt
    s_nop 2
    v_permlane16_swap_b32 v34, v35
    v_add_f32 v34, v34, v35
    s_nop 1
    v_add_f32_dpp v32, v32, v32 row_ror:8 row_mask:0xf bank_mask:0x3
    v_add_f32_dpp v32, v34, v34 row_ror:8 row_mask:0xf bank_mask:0xc
    v_mov_b32 v36, 0
    s_waitcnt vmcnt(4)
    v_dot2c_f32_bf16 v36, v128, v12
    v_dot2c_f32_bf16 v36, v129, v13
    v_dot2c_f32_bf16 v36, v130, v14
    v_dot2c_f32_bf16 v36, v131, v15
    s_add_u32 s54, s53, 16384
    buffer_load_dwordx4 v[128:131], v2, s[32:35], s54 offen offset:0 nt
    v_mov_b32 v37, 0
    s_waitcnt vmcnt(4)
    v_dot2c_f32_bf16 v37, v132, v12
    v_dot2c_f32_bf16 v37, v133, v13
    v_dot2c_f32_bf16 v37, v134, v14
    v_dot2c_f32_bf16 v37, v135, v15
    s_add_u32 s54, s53, 20480
    buffer_load_dwordx4 v[132:135], v2, s[32:35], s54 offen offset:0 nt
    s_nop 2
    v_permlane16_swap_b32 v36, v37
    v_add_f32 v36, v36, v37
    v_mov_b32 v38, 0
    s_waitcnt vmcnt(4)
    v_dot2c_f32_bf16 v38, v136, v12
    v_dot2c_f32_bf16 v38, v137, v13
    v_dot2c_f32_bf16 v38, v138, v14
    v_dot2c_f32_bf16 v38, v139, v15
    s_add_u32 s54, s53, 24576
    buffer_load_dwordx4 v[136:139], v2, s[32:35], s54 offen offset:0 nt
    v_mov_b32 v39, 0
    s_waitcnt vmcnt(4)
    v_dot2c_f32_bf16 v39, v140, v12
    v_dot2c_f32_bf16 v39, v141, v13
    v_dot2c_f32_bf16 v39, v142, v14
    v_dot2c_f32_bf16 v39, v143, v15
    s_add_u32 s54, s53, 28672
    buffer_load_dwordx4 v[140:143], v2, s[32:35], s54 offen offset:0 nt
    s_nop 2
    v_permlane16_swap_b32 v38, v39
    v_add_f32 v38, v38, v39
    s_nop 1
    v_add_f32_dpp v36, v36, v36 row_ror:8 row_mask:0xf bank_mask:0x3
    v_add_f32_dpp v36, v38, v38 row_ror:8 row_mask:0xf bank_mask:0xc
    s_nop 1
    v_add_f32_dpp v32, v32, v32 row_shl:4 row_mask:0xf bank_mask:0x5
    v_add_f32_dpp v32, v36, v36 row_shr:4 row_mask:0xf bank_mask:0xa
    v_mov_b32 v33, 0
    s_waitcnt vmcnt(4)
    v_dot2c_f32_bf16 v33, v144, v12
    v_dot2c_f32_bf16 v33, v145, v13
    v_dot2c_f32_bf16 v33, v146, v14
    v_dot2c_f32_bf16 v33, v147, v15
    s_add_u32 s54, s53, 32768
    buffer_load_dwordx4 v[144:147], v2, s[32:35], s54 offen offset:0 nt
    v_mov_b32 v35, 0
    s_waitcnt vmcnt(4)
    v_dot2c_f32_bf16 v35, v148, v12
    v_dot2c_f32_bf16 v35, v149, v13
    v_dot2c_f32_bf16 v35, v150, v14
    v_dot2c_f32_bf16 v35, v151, v15
    s_add_u32 s54, s53, 36864
    buffer_load_dwordx4 v[148:151], v2, s[32:35], s54 offen offset:0 nt
    s_nop 2
    v_permlane16_swap_b32 v33, v35
    v_add_f32 v33, v33, v35
    v_mov_b32 v34, 0
    s_waitcnt vmcnt(4)
    v_dot2c_f32_bf16 v34, v152, v12
    v_dot2c_f32_bf16 v34, v153, v13
    v_dot2c_f32_bf16 v34, v154, v14
    v_dot2c_f32_bf16 v34, v155, v15
    s_add_u32 s54, s53, 40960
    buffer_load_dwordx4 v[152:155], v2, s[32:35], s54 offen offset:0 nt
    v_mov_b32 v37, 0
    s_waitcnt vmcnt(4)
    v_dot2c_f32_bf16 v37, v156, v12
    v_dot2c_f32_bf16 v37, v157, v13
    v_dot2c_f32_bf16 v37, v158, v14
    v_dot2c_f32_bf16 v37, v159, v15
    s_add_u32 s54, s53, 45056
    buffer_load_dwordx4 v[156:159], v2, s[32:35], s54 offen offset:0 nt
    s_nop 2
    v_permlane16_swap_b32 v34, v37
    v_add_f32 v34, v34, v37
    s_nop 1
    v_add_f32_dpp v33, v33, v33 row_ror:8 row_mask:0xf bank_mask:0x3
    v_add_f32_dpp v33, v34, v34 row_ror:8 row_mask:0xf bank_mask:0xc
    v_mov_b32 v39, 0
    s_waitcnt vmcnt(4)
    v_dot2c_f32_bf16 v39, v160, v12
    v_dot2c_f32_bf16 v39, v161, v13
    v_dot2c_f32_bf16 v39, v162, v14
    v_dot2c_f32_bf16 v39, v163, v15
    s_add_u32 s54, s53, 49152
    buffer_load_dwordx4 v[160:163], v2, s[32:35], s54 offen offset:0 nt
    v_mov_b32 v38, 0
    s_waitcnt vmcnt(4)
    v_dot2c_f32_bf16 v38, v164, v12
    v_dot2c_f32_bf16 v38, v165, v13
    v_dot2c_f32_bf16 v38, v166, v14
    v_dot2c_f32_bf16 v38, v167, v15
    s_add_u32 s54, s53, 53248
    buffer_load_dwordx4 v[164:167], v2, s[32:35], s54 offen offset:0 nt
    s_nop 2
    v_permlane16_swap_b32 v39, v38
    v_add_f32 v39, v39, v38
    v_mov_b32 v36, 0
    s_waitcnt vmcnt(4)
    v_dot2c_f32_bf16 v36, v168, v12
    v_dot2c_f32_bf16 v36, v169, v13
    v_dot2c_f32_bf16 v36, v170, v14
    v_dot2c_f32_bf16 v36, v171, v15
    s_add_u32 s54, s53, 57344
    buffer_load_dwordx4 v[168:171], v2, s[32:35], s54 offen offset:0 nt
    v_mov_b32 v35, 0
    s_waitcnt vmcnt(4)
    v_dot2c_f32_bf16 v35, v172, v12
    v_dot2c_f32_bf16 v35, v173, v13
    v_dot2c_f32_bf16 v35, v174, v14
    v_dot2c_f32_bf16 v35, v175, v15
    s_add_u32 s54, s53, 61440
    buffer_load_dwordx4 v[172:175], v2, s[32:35], s54 offen offset:0 nt
    s_nop 2
    v_permlane16_swap_b32 v36, v35
    v_add_f32 v36, v36, v35
    s_nop 1
    v_add_f32_dpp v39, v39, v39 row_ror:8 row_mask:0xf bank_mask:0x3
    v_add_f32_dpp v39, v36, v36 row_ror:8 row_mask:0xf bank_mask:0xc
    s_nop 1
    v_add_f32_dpp v33, v33, v33 row_shl:4 row_mask:0xf bank_mask:0x5
    v_add_f32_dpp v33, v39, v39 row_shr:4 row_mask:0xf bank_mask:0xa
    s_nop 1
    v_add_f32_dpp v32, v32, v32 quad_perm:[2,3,0,1] row_mask:0xf bank_mask:0xf
    v_add_f32_dpp v33, v33, v33 quad_perm:[2,3,0,1] row_mask:0xf bank_mask:0xf
    v_cndmask_b32 v32, v32, v33, s[56:57]
    v_mov_b32 v37, 0
    s_waitcnt vmcnt(4)
    v_dot2c_f32_bf16 v37, v176, v12
    v_dot2c_f32_bf16 v37, v177, v13
    v_dot2c_f32_bf16 v37, v178, v14
    v_dot2c_f32_bf16 v37, v179, v15
    s_add_u32 s54, s53, 65536
    buffer_load_dwordx4 v[176:179], v2, s[32:35], s54 offen offset:0 nt
    v_mov_b32 v34, 0
    s_waitcnt vmcnt(4)
    v_dot2c_f32_bf16 v34, v180, v12
    v_dot2c_f32_bf16 v34, v181, v13
    v_dot2c_f32_bf16 v34, v182, v14
    v_dot2c_f32_bf16 v34, v183, v15
    s_add_u32 s54, s53, 69632
    buffer_load_dwordx4 v[180:183], v2, s[32:35], s54 offen offset:0 nt
    s_nop 2
    v_permlane16_swap_b32 v37, v34
    v_add_f32 v37, v37, v34
    v_mov_b32 v38, 0
    s_waitcnt vmcnt(4)
    v_dot2c_f32_bf16 v38, v184, v12
    v_dot2c_f32_bf16 v38, v185, v13
    v_dot2c_f32_bf16 v38, v186, v14
    v_dot2c_f32_bf16 v38, v187, v15
    s_add_u32 s54, s53, 73728
    buffer_load_dwordx4 v[184:187], v2, s[32:35], s54 offen offset:0 nt
    v_mov_b32 v35, 0
    s_waitcnt vmcnt(4)
    v_dot2c_f32_bf16 v35, v188, v12
    v_dot2c_f32_bf16 v35, v189, v13
    v_dot2c_f32_bf16 v35, v190, v14
    v_dot2c_f32_bf16 v35, v191, v15
    s_add_u32 s54, s53, 77824
    buffer_load_dwordx4 v[188:191], v2, s[32:35], s54 offen offset:0 nt
    s_nop 2
    v_permlane16_swap_b32 v38, v35
    v_add_f32 v38, v38, v35
    s_nop 1
    v_add_f32_dpp v37, v37, v37 row_ror:8 row_mask:0xf bank_mask:0x3
    v_add_f32_dpp v37, v38, v38 row_ror:8 row_mask:0xf bank_mask:0xc
    v_mov_b32 v36, 0
    s_waitcnt vmcnt(4)
    v_dot2c_f32_bf16 v36, v192, v12
    v_dot2c_f32_bf16 v36, v193, v13
    v_dot2c_f32_bf16 v36, v194, v14
    v_dot2c_f32_bf16 v36, v195, v15
    s_add_u32 s54, s53, 81920
    buffer_load_dwordx4 v[192:195], v2, s[32:35], s54 offen offset:0 nt
    v_mov_b32 v39, 0
    s_waitcnt vmcnt(4)
    v_dot2c_f32_bf16 v39, v196, v12
    v_dot2c_f32_bf16 v39, v197, v13
    v_dot2c_f32_bf16 v39, v198, v14
    v_dot2c_f32_bf16 v39, v199, v15
    s_add_u32 s54, s53, 86016
    buffer_load_dwordx4 v[196:199], v2, s[32:35], s54 offen offset:0 nt
    s_nop 2
    v_permlane16_swap_b32 v36, v39
    v_add_f32 v36, v36, v39
    v_mov_b32 v33, 0
    s_waitcnt vmcnt(4)
    v_dot2c_f32_bf16 v33, v200, v12
    v_dot2c_f32_bf16 v33, v201, v13
    v_dot2c_f32_bf16 v33, v202, v14
    v_dot2c_f32_bf16 v33, v203, v15
    s_add_u32 s54, s53, 90112
    buffer_load_dwordx4 v[200:203], v2, s[32:35], s54 offen offset:0 nt
    v_mov_b32 v34, 0
    s_waitcnt vmcnt(4)
    v_dot2c_f32_bf16 v34, v204, v12
    v_dot2c_f32_bf16 v34, v205, v13
    v_dot2c_f32_bf16 v34, v206, v14
    v_dot2c_f32_bf16 v34, v207, v15
    s_add_u32 s54, s53, 94208
    buffer_load_dwordx4 v[204:207], v2, s[32:35], s54 offen offset:0 nt
    s_nop 2
    v_permlane16_swap_b32 v33, v34
    v_add_f32 v33, v33, v34
    s_nop 1
    v_add_f32_dpp v36, v36, v36 row_ror:8 row_mask:0xf bank_mask:0x3
    v_add_f32_dpp v36, v33, v33 row_ror:8 row_mask:0xf bank_mask:0xc
    s_nop 1
    v_add_f32_dpp v37, v37, v37 row_shl:4 row_mask:0xf bank_mask:0x5
    v_add_f32_dpp v37, v36, v36 row_shr:4 row_mask:0xf bank_mask:0xa
    v_mov_b32 v35, 0
    s_waitcnt vmcnt(4)
    v_dot2c_f32_bf16 v35, v208, v12
    v_dot2c_f32_bf16 v35, v209, v13
    v_dot2c_f32_bf16 v35, v210, v14
    v_dot2c_f32_bf16 v35, v211, v15
    s_add_u32 s54, s53, 98304
    buffer_load_dwordx4 v[208:211], v2, s[32:35], s54 offen offset:0 nt
    v_mov_b32 v38, 0
    s_waitcnt vmcnt(4)
    v_dot2c_f32_bf16 v38, v212, v12
    v_dot2c_f32_bf16 v38, v213, v13
    v_dot2c_f32_bf16 v38, v214, v14
    v_dot2c_f32_bf16 v38, v215, v15
    s_add_u32 s54, s53, 102400
    buffer_load_dwordx4 v[212:215], v2, s[32:35], s54 offen offset:0 nt
    s_nop 2
    v_permlane16_swap_b32 v35, v38
    v_add_f32 v35, v35, v38
    v_mov_b32 v39, 0
    s_waitcnt vmcnt(4)
    v_dot2c_f32_bf16 v39, v216, v12
    v_dot2c_f32_bf16 v39, v217, v13
    v_dot2c_f32_bf16 v39, v218, v14
    v_dot2c_f32_bf16 v39, v219, v15
    s_add_u32 s54, s53, 106496
    buffer_load_dwordx4 v[216:219], v2, s[32:35], s54 offen offset:0 nt
    v_mov_b32 v34, 0
    s_waitcnt vmcnt(4)
    v_dot2c_f32_bf16 v34, v220, v12
    v_dot2c_f32_bf16 v34, v221, v13
    v_dot2c_f32_bf16 v34, v222, v14
    v_dot2c_f32_bf16 v34, v223, v15
    s_add_u32 s54, s53, 110592
    buffer_load_dwordx4 v[220:223], v2, s[32:35], s54 offen offset:0 nt
    s_nop 2
    v_permlane16_swap_b32 v39, v34
    v_add_f32 v39, v39, v34
    s_nop 1
    v_add_f32_dpp v35, v35, v35 row_ror:8 row_mask:0xf bank_mask:0x3
    v_add_f32_dpp v35, v39, v39 row_ror:8 row_mask:0xf bank_mask:0xc
    v_mov_b32 v33, 0
    s_waitcnt vmcnt(4)
    v_dot2c_f32_bf16 v33, v224, v12
    v_dot2c_f32_bf16 v33, v225, v13
    v_dot2c_f32_bf16 v33, v226, v14
    v_dot2c_f32_bf16 v33, v227, v15
    s_add_u32 s54, s53, 114688
    buffer_load_dwordx4 v[224:227], v2, s[32:35], s54 offen offset:0 nt
    v_mov_b32 v36, 0
    s_waitcnt vmcnt(4)
    v_dot2c_f32_bf16 v36, v228, v12
    v_dot2c_f32_bf16 v36, v229, v13
    v_dot2c_f32_bf16 v36, v230, v14
    v_dot2c_f32_bf16 v36, v231, v15
    s_add_u32 s54, s53, 118784
    buffer_load_dwordx4 v[228:231], v2, s[32:35], s54 offen offset:0 nt
    s_nop 2
    v_permlane16_swap_b32 v33, v36
    v_add_f32 v33, v33, v36
    v_mov_b32 v38, 0
    s_waitcnt vmcnt(4)
    v_dot2c_f32_bf16 v38, v232, v12
    v_dot2c_f32_bf16 v38, v233, v13
    v_dot2c_f32_bf16 v38, v234, v14
    v_dot2c_f32_bf16 v38, v235, v15
    s_add_u32 s54, s53, 122880
    buffer_load_dwordx4 v[232:235], v2, s[32:35], s54 offen offset:0 nt
    v_mov_b32 v34, 0
    s_waitcnt vmcnt(4)
    v_dot2c_f32_bf16 v34, v236, v12
    v_dot2c_f32_bf16 v34, v237, v13
    v_dot2c_f32_bf16 v34, v238, v14
    v_dot2c_f32_bf16 v34, v239, v15
    s_add_u32 s54, s53, 126976
    buffer_load_dwordx4 v[236:239], v2, s[32:35], s54 offen offset:0 nt
    s_nop 2
    v_permlane16_swap_b32 v38, v34
    v_add_f32 v38, v38, v34
    s_nop 1
    v_add_f32_dpp v33, v33, v33 row_ror:8 row_mask:0xf bank_mask:0x3
    v_add_f32_dpp v33, v38, v38 row_ror:8 row_mask:0xf bank_mask:0xc
    s_nop 1
    v_add_f32_dpp v35, v35, v35 row_shl:4 row_mask:0xf bank_mask:0x5
    v_add_f32_dpp v35, v33, v33 row_shr:4 row_mask:0xf bank_mask:0xa
    s_nop 1
    v_add_f32_dpp v37, v37, v37 quad_perm:[2,3,0,1] row_mask:0xf bank_mask:0xf
    v_add_f32_dpp v35, v35, v35 quad_perm:[2,3,0,1] row_mask:0xf bank_mask:0xf
    v_cndmask_b32 v37, v37, v35, s[56:57]
    s_nop 1
    v_add_f32_dpp v32, v32, v32 quad_perm:[1,0,3,2] row_mask:0xf bank_mask:0xf
    v_add_f32_dpp v37, v37, v37 quad_perm:[1,0,3,2] row_mask:0xf bank_mask:0xf
    v_cndmask_b32 v32, v32, v37, s[58:59]
    v_mov_b32 v16, v17
    v_mov_b32 v17, v18
    v_mov_b32 v18, v19
    v_mov_b32 v19, v20
    v_mov_b32 v20, v21
    v_mov_b32 v21, v22
    v_mov_b32 v22, v23
    v_mov_b32 v23, v32
    s_add_u32 s55, s55, 1
    s_cmp_lt_u32 s55, 8
    s_cbranch_scc1 L_kloop
    v_cvt_pk_bf16_f32 v4, v16, v17
    v_lshlrev_b32 v16, 16, v4
    v_and_b32 v17, 0xffff0000, v4
    v_cvt_pk_bf16_f32 v4, v18, v19
    v_lshlrev_b32 v18, 16, v4
    v_and_b32 v19, 0xffff0000, v4
    v_cvt_pk_bf16_f32 v4, v20, v21
    v_lshlrev_b32 v20, 16, v4
    v_and_b32 v21, 0xffff0000, v4
    v_cvt_pk_bf16_f32 v4, v22, v23
    v_lshlrev_b32 v22, 16, v4
    v_and_b32 v23, 0xffff0000, v4
    v_max3_f32 v40, v16, v17, v18
    v_max3_f32 v40, v40, v19, v20
    v_max3_f32 v40, v40, v21, v22
    v_max_f32 v40, v40, v23
    s_nop 1
    v_max_f32_dpp v40, v40, v40 row_ror:8 row_mask:0xf bank_mask:0xf
    s_nop 1
    v_max_f32_dpp v40, v40, v40 row_ror:4 row_mask:0xf bank_mask:0xf
    s_nop 1
    v_max_f32_dpp v40, v40, v40 row_ror:2 row_mask:0xf bank_mask:0xf
    s_nop 1
    v_max_f32_dpp v40, v40, v40 row_ror:1 row_mask:0xf bank_mask:0xf
    v_mov_b32 v7, v40
    s_nop 1
    v_permlane16_swap_b32 v40, v7
    v_max_f32 v40, v40, v7
    v_mov_b32 v7, v40
    s_nop 1
    v_permlane32_swap_b32 v40, v7
    v_max_f32 v40, v40, v7
    v_sub_f32 v16, v16, v40
    v_mul_f32 v16, 0.09016844005556021, v16
    v_exp_f32 v16, v16
    v_sub_f32 v17, v17, v40
    v_mul_f32 v17, 0.09016844005556021, v17
    v_exp_f32 v17, v17
    v_sub_f32 v18, v18, v40
    v_mul_f32 v18, 0.09016844005556021, v18
    v_exp_f32 v18, v18
    v_sub_f32 v19, v19, v40
    v_mul_f32 v19, 0.09016844005556021, v19
    v_exp_f32 v19, v19
    v_sub_f32 v20, v20, v40
    v_mul_f32 v20, 0.09016844005556021, v20
    v_exp_f32 v20, v20
    v_sub_f32 v21, v21, v40
    v_mul_f32 v21, 0.09016844005556021, v21
    v_exp_f32 v21, v21
    v_sub_f32 v22, v22, v40
    v_mul_f32 v22, 0.09016844005556021, v22
    v_exp_f32 v22, v22
    v_sub_f32 v23, v23, v40
    v_mul_f32 v23, 0.09016844005556021, v23
    v_exp_f32 v23, v23
    s_nop 0
    v_add_f32 v41, v16, v17
    v_add_f32 v41, v41, v18
    v_add_f32 v41, v41, v19
    v_add_f32 v41, v41, v20
    v_add_f32 v41, v41, v21
    v_add_f32 v41, v41, v22
    v_add_f32 v41, v41, v23
    v_cvt_pk_bf16_f32 v16, v16, 0
    ds_write_b32 v8, v16 offset:22528
    v_cvt_pk_bf16_f32 v17, v17, 0
    ds_write_b32 v8, v17 offset:22656
    v_cvt_pk_bf16_f32 v18, v18, 0
    ds_write_b32 v8, v18 offset:22784
    v_cvt_pk_bf16_f32 v19, v19, 0
    ds_write_b32 v8, v19 offset:22912
    v_cvt_pk_bf16_f32 v20, v20, 0
    ds_write_b32 v8, v20 offset:23040
    v_cvt_pk_bf16_f32 v21, v21, 0
    ds_write_b32 v8, v21 offset:23168
    v_cvt_pk_bf16_f32 v22, v22, 0
    ds_write_b32 v8, v22 offset:23296
    v_cvt_pk_bf16_f32 v23, v23, 0
    ds_write_b32 v8, v23 offset:23424
    s_nop 1
    v_add_f32_dpp v41, v41, v41 row_ror:8 row_mask:0xf bank_mask:0xf
    s_nop 1
    v_add_f32_dpp v41, v41, v41 row_ror:4 row_mask:0xf bank_mask:0xf
    s_nop 1
    v_add_f32_dpp v41, v41, v41 row_ror:2 row_mask:0xf bank_mask:0xf
    s_nop 1
    v_add_f32_dpp v41, v41, v41 row_ror:1 row_mask:0xf bank_mask:0xf
    v_mov_b32 v7, v41
    s_nop 1
    v_permlane16_swap_b32 v41, v7
    v_add_f32 v41, v41, v7
    v_mov_b32 v7, v41
    s_nop 1
    v_permlane32_swap_b32 v41, v7
    v_add_f32 v41, v41, v7
    s_lshl_b32 s54, s52, 3
    v_mov_b32 v4, s54
    ds_write_b64 v4, v[40:41] offset:2624
    v_mov_b32 v24, 0
    v_mov_b32 v25, 0
    v_mov_b32 v26, 0
    v_mov_b32 v27, 0
    v_mov_b32 v28, 0
    v_mov_b32 v29, 0
    v_mov_b32 v30, 0
    v_mov_b32 v31, 0
    s_waitcnt lgkmcnt(0)
    s_mov_b32 s55, 0
L_vloop:
    ds_read_b128 v[52:55], v9 offset:22528
    ds_read_b128 v[56:59], v9 offset:22544
    ds_read_b128 v[60:63], v9 offset:22560
    ds_read_b128 v[64:67], v9 offset:22576
    ds_read_b128 v[68:71], v9 offset:22592
    ds_read_b128 v[72:75], v9 offset:22608
    ds_read_b128 v[76:79], v9 offset:22624
    ds_read_b128 v[80:83], v9 offset:22640
    v_mov_b32 v6, 0
    ds_read_b32 v43, v6 offset:2704
    v_add_u32 v9, 128, v9
    s_add_u32 s53, s53, 131072
    s_waitcnt lgkmcnt(0)
    v_lshlrev_b32 v6, 16, v52
    s_waitcnt vmcnt(4)
    v_dot2c_f32_bf16 v24, v112, v52
    v_dot2c_f32_bf16 v25, v112, v6
    v_dot2c_f32_bf16 v26, v113, v52
    v_dot2c_f32_bf16 v27, v113, v6
    v_dot2c_f32_bf16 v28, v114, v52
    v_dot2c_f32_bf16 v29, v114, v6
    v_dot2c_f32_bf16 v30, v115, v52
    v_dot2c_f32_bf16 v31, v115, v6
    buffer_load_dwordx4 v[112:115], v2, s[32:35], s53 offen offset:0 nt
    v_lshlrev_b32 v6, 16, v53
    s_waitcnt vmcnt(4)
    v_dot2c_f32_bf16 v24, v116, v53
    v_dot2c_f32_bf16 v25, v116, v6
    v_dot2c_f32_bf16 v26, v117, v53
    v_dot2c_f32_bf16 v27, v117, v6
    v_dot2c_f32_bf16 v28, v118, v53
    v_dot2c_f32_bf16 v29, v118, v6
    v_dot2c_f32_bf16 v30, v119, v53
    v_dot2c_f32_bf16 v31, v119, v6
    s_add_u32 s54, s53, 4096
    buffer_load_dwordx4 v[116:119], v2, s[32:35], s54 offen offset:0 nt
    v_lshlrev_b32 v6, 16, v54
    s_waitcnt vmcnt(4)
    v_dot2c_f32_bf16 v24, v120, v54
    v_dot2c_f32_bf16 v25, v120, v6
    v_dot2c_f32_bf16 v26, v121, v54
    v_dot2c_f32_bf16 v27, v121, v6
    v_dot2c_f32_bf16 v28, v122, v54
    v_dot2c_f32_bf16 v29, v122, v6
    v_dot2c_f32_bf16 v30, v123, v54
    v_dot2c_f32_bf16 v31, v123, v6
    s_add_u32 s54, s53, 8192
    buffer_load_dwordx4 v[120:123], v2, s[32:35], s54 offen offset:0 nt
    v_lshlrev_b32 v6, 16, v55
    s_waitcnt vmcnt(4)
    v_dot2c_f32_bf16 v24, v124, v55
    v_dot2c_f32_bf16 v25, v124, v6
    v_dot2c_f32_bf16 v26, v125, v55
    v_dot2c_f32_bf16 v27, v125, v6
    v_dot2c_f32_bf16 v28, v126, v55
    v_dot2c_f32_bf16 v29, v126, v6
    v_dot2c_f32_bf16 v30, v127, v55
    v_dot2c_f32_bf16 v31, v127, v6
    s_add_u32 s54, s53, 12288
    buffer_load_dwordx4 v[124:127], v2, s[32:35], s54 offen offset:0 nt
    v_lshlrev_b32 v6, 16, v56
    s_waitcnt vmcnt(4)
    v_dot2c_f32_bf16 v24, v128, v56
    v_dot2c_f32_bf16 v25, v128, v6
    v_dot2c_f32_bf16 v26, v129, v56
    v_dot2c_f32_bf16 v27, v129, v6
    v_dot2c_f32_bf16 v28, v130, v56
    v_dot2c_f32_bf16 v29, v130, v6
    v_dot2c_f32_bf16 v30, v131, v56
    v_dot2c_f32_bf16 v31, v131, v6
    s_add_u32 s54, s53, 16384
    buffer_load_dwordx4 v[128:131], v2, s[32:35], s54 offen offset:0 nt
    v_lshlrev_b32 v6, 16, v57
    s_waitcnt vmcnt(4)
    v_dot2c_f32_bf16 v24, v132, v57
    v_dot2c_f32_bf16 v25, v132, v6
    v_dot2c_f32_bf16 v26, v133, v57
    v_dot2c_f32_bf16 v27, v133, v6
    v_dot2c_f32_bf16 v28, v134, v57
    v_dot2c_f32_bf16 v29, v134, v6
    v_dot2c_f32_bf16 v30, v135, v57
    v_dot2c_f32_bf16 v31, v135, v6
    s_add_u32 s54, s53, 20480
    buffer_load_dwordx4 v[132:135], v2, s[32:35], s54 offen offset:0 nt
    v_lshlrev_b32 v6, 16, v58
    s_waitcnt vmcnt(4)
    v_dot2c_f32_bf16 v24, v136, v58
    v_dot2c_f32_bf16 v25, v136, v6
    v_dot2c_f32_bf16 v26, v137, v58
    v_dot2c_f32_bf16 v27, v137, v6
    v_dot2c_f32_bf16 v28, v138, v58
    v_dot2c_f32_bf16 v29, v138, v6
    v_dot2c_f32_bf16 v30, v139, v58
    v_dot2c_f32_bf16 v31, v139, v6
    s_add_u32 s54, s53, 24576
    buffer_load_dwordx4 v[136:139], v2, s[32:35], s54 offen offset:0 nt
    v_lshlrev_b32 v6, 16, v59
    s_waitcnt vmcnt(4)
    v_dot2c_f32_bf16 v24, v140, v59
    v_dot2c_f32_bf16 v25, v140, v6
    v_dot2c_f32_bf16 v26, v141, v59
    v_dot2c_f32_bf16 v27, v141, v6
    v_dot2c_f32_bf16 v28, v142, v59
    v_dot2c_f32_bf16 v29, v142, v6
    v_dot2c_f32_bf16 v30, v143, v59
    v_dot2c_f32_bf16 v31, v143, v6
    s_add_u32 s54, s53, 28672
    buffer_load_dwordx4 v[140:143], v2, s[32:35], s54 offen offset:0 nt
    v_lshlrev_b32 v6, 16, v60
    s_waitcnt vmcnt(4)
    v_dot2c_f32_bf16 v24, v144, v60
    v_dot2c_f32_bf16 v25, v144, v6
    v_dot2c_f32_bf16 v26, v145, v60
    v_dot2c_f32_bf16 v27, v145, v6
    v_dot2c_f32_bf16 v28, v146, v60
    v_dot2c_f32_bf16 v29, v146, v6
    v_dot2c_f32_bf16 v30, v147, v60
    v_dot2c_f32_bf16 v31, v147, v6
    s_add_u32 s54, s53, 32768
    buffer_load_dwordx4 v[144:147], v2, s[32:35], s54 offen offset:0 nt
    v_lshlrev_b32 v6, 16, v61
    s_waitcnt vmcnt(4)
    v_dot2c_f32_bf16 v24, v148, v61
    v_dot2c_f32_bf16 v25, v148, v6
    v_dot2c_f32_bf16 v26, v149, v61
    v_dot2c_f32_bf16 v27, v149, v6
    v_dot2c_f32_bf16 v28, v150, v61
    v_dot2c_f32_bf16 v29, v150, v6
    v_dot2c_f32_bf16 v30, v151, v61
    v_dot2c_f32_bf16 v31, v151, v6
    s_add_u32 s54, s53, 36864
    buffer_load_dwordx4 v[148:151], v2, s[32:35], s54 offen offset:0 nt
    v_lshlrev_b32 v6, 16, v62
    s_waitcnt vmcnt(4)
    v_dot2c_f32_bf16 v24, v152, v62
    v_dot2c_f32_bf16 v25, v152, v6
    v_dot2c_f32_bf16 v26, v153, v62
    v_dot2c_f32_bf16 v27, v153, v6
    v_dot2c_f32_bf16 v28, v154, v62
    v_dot2c_f32_bf16 v29, v154, v6
    v_dot2c_f32_bf16 v30, v155, v62
    v_dot2c_f32_bf16 v31, v155, v6
    s_add_u32 s54, s53, 40960
    buffer_load_dwordx4 v[152:155], v2, s[32:35], s54 offen offset:0 nt
    v_lshlrev_b32 v6, 16, v63
    s_waitcnt vmcnt(4)
    v_dot2c_f32_bf16 v24, v156, v63
    v_dot2c_f32_bf16 v25, v156, v6
    v_dot2c_f32_bf16 v26, v157, v63
    v_dot2c_f32_bf16 v27, v157, v6
    v_dot2c_f32_bf16 v28, v158, v63
    v_dot2c_f32_bf16 v29, v158, v6
    v_dot2c_f32_bf16 v30, v159, v63
    v_dot2c_f32_bf16 v31, v159, v6
    s_add_u32 s54, s53, 45056
    buffer_load_dwordx4 v[156:159], v2, s[32:35], s54 offen offset:0 nt
    v_lshlrev_b32 v6, 16, v64
    s_waitcnt vmcnt(4)
    v_dot2c_f32_bf16 v24, v160, v64
    v_dot2c_f32_bf16 v25, v160, v6
    v_dot2c_f32_bf16 v26, v161, v64
    v_dot2c_f32_bf16 v27, v161, v6
    v_dot2c_f32_bf16 v28, v162, v64
    v_dot2c_f32_bf16 v29, v162, v6
    v_dot2c_f32_bf16 v30, v163, v64
    v_dot2c_f32_bf16 v31, v163, v6
    s_add_u32 s54, s53, 49152
    buffer_load_dwordx4 v[160:163], v2, s[32:35], s54 offen offset:0 nt
    v_lshlrev_b32 v6, 16, v65
    s_waitcnt vmcnt(4)
    v_dot2c_f32_bf16 v24, v164, v65
    v_dot2c_f32_bf16 v25, v164, v6
    v_dot2c_f32_bf16 v26, v165, v65
    v_dot2c_f32_bf16 v27, v165, v6
    v_dot2c_f32_bf16 v28, v166, v65
    v_dot2c_f32_bf16 v29, v166, v6
    v_dot2c_f32_bf16 v30, v167, v65
    v_dot2c_f32_bf16 v31, v167, v6
    s_add_u32 s54, s53, 53248
    buffer_load_dwordx4 v[164:167], v2, s[32:35], s54 offen offset:0 nt
    v_lshlrev_b32 v6, 16, v66
    s_waitcnt vmcnt(4)
    v_dot2c_f32_bf16 v24, v168, v66
    v_dot2c_f32_bf16 v25, v168, v6
    v_dot2c_f32_bf16 v26, v169, v66
    v_dot2c_f32_bf16 v27, v169, v6
    v_dot2c_f32_bf16 v28, v170, v66
    v_dot2c_f32_bf16 v29, v170, v6
    v_dot2c_f32_bf16 v30, v171, v66
    v_dot2c_f32_bf16 v31, v171, v6
    s_add_u32 s54, s53, 57344
    buffer_load_dwordx4 v[168:171], v2, s[32:35], s54 offen offset:0 nt
    v_lshlrev_b32 v6, 16, v67
    s_waitcnt vmcnt(4)
    v_dot2c_f32_bf16 v24, v172, v67
    v_dot2c_f32_bf16 v25, v172, v6
    v_dot2c_f32_bf16 v26, v173, v67
    v_dot2c_f32_bf16 v27, v173, v6
    v_dot2c_f32_bf16 v28, v174, v67
    v_dot2c_f32_bf16 v29, v174, v6
    v_dot2c_f32_bf16 v30, v175, v67
    v_dot2c_f32_bf16 v31, v175, v6
    s_add_u32 s54, s53, 61440
    buffer_load_dwordx4 v[172:175], v2, s[32:35], s54 offen offset:0 nt
    v_lshlrev_b32 v6, 16, v68
    s_waitcnt vmcnt(4)
    v_dot2c_f32_bf16 v24, v176, v68
    v_dot2c_f32_bf16 v25, v176, v6
    v_dot2c_f32_bf16 v26, v177, v68
    v_dot2c_f32_bf16 v27, v177, v6
    v_dot2c_f32_bf16 v28, v178, v68
    v_dot2c_f32_bf16 v29, v178, v6
    v_dot2c_f32_bf16 v30, v179, v68
    v_dot2c_f32_bf16 v31, v179, v6
    s_add_u32 s54, s53, 65536
    buffer_load_dwordx4 v[176:179], v2, s[32:35], s54 offen offset:0 nt
    v_lshlrev_b32 v6, 16, v69
    s_waitcnt vmcnt(4)
    v_dot2c_f32_bf16 v24, v180, v69
    v_dot2c_f32_bf16 v25, v180, v6
    v_dot2c_f32_bf16 v26, v181, v69
    v_dot2c_f32_bf16 v27, v181, v6
    v_dot2c_f32_bf16 v28, v182, v69
    v_dot2c_f32_bf16 v29, v182, v6
    v_dot2c_f32_bf16 v30, v183, v69
    v_dot2c_f32_bf16 v31, v183, v6
    s_add_u32 s54, s53, 69632
    buffer_load_dwordx4 v[180:183], v2, s[32:35], s54 offen offset:0 nt
    v_lshlrev_b32 v6, 16, v70
    s_waitcnt vmcnt(4)
    v_dot2c_f32_bf16 v24, v184, v70
    v_dot2c_f32_bf16 v25, v184, v6
    v_dot2c_f32_bf16 v26, v185, v70
    v_dot2c_f32_bf16 v27, v185, v6
    v_dot2c_f32_bf16 v28, v186, v70
    v_dot2c_f32_bf16 v29, v186, v6
    v_dot2c_f32_bf16 v30, v187, v70
    v_dot2c_f32_bf16 v31, v187, v6
    s_add_u32 s54, s53, 73728
    buffer_load_dwordx4 v[184:187], v2, s[32:35], s54 offen offset:0 nt
    v_lshlrev_b32 v6, 16, v71
    s_waitcnt vmcnt(4)
    v_dot2c_f32_bf16 v24, v188, v71
    v_dot2c_f32_bf16 v25, v188, v6
    v_dot2c_f32_bf16 v26, v189, v71
    v_dot2c_f32_bf16 v27, v189, v6
    v_dot2c_f32_bf16 v28, v190, v71
    v_dot2c_f32_bf16 v29, v190, v6
    v_dot2c_f32_bf16 v30, v191, v71
    v_dot2c_f32_bf16 v31, v191, v6
    s_add_u32 s54, s53, 77824
    buffer_load_dwordx4 v[188:191], v2, s[32:35], s54 offen offset:0 nt
    v_lshlrev_b32 v6, 16, v72
    s_waitcnt vmcnt(4)
    v_dot2c_f32_bf16 v24, v192, v72
    v_dot2c_f32_bf16 v25, v192, v6
    v_dot2c_f32_bf16 v26, v193, v72
    v_dot2c_f32_bf16 v27, v193, v6
    v_dot2c_f32_bf16 v28, v194, v72
    v_dot2c_f32_bf16 v29, v194, v6
    v_dot2c_f32_bf16 v30, v195, v72
    v_dot2c_f32_bf16 v31, v195, v6
    s_add_u32 s54, s53, 81920
    buffer_load_dwordx4 v[192:195], v2, s[32:35], s54 offen offset:0 nt
    v_lshlrev_b32 v6, 16, v73
    s_waitcnt vmcnt(4)
    v_dot2c_f32_bf16 v24, v196, v73
    v_dot2c_f32_bf16 v25, v196, v6
    v_dot2c_f32_bf16 v26, v197, v73
    v_dot2c_f32_bf16 v27, v197, v6
    v_dot2c_f32_bf16 v28, v198, v73
    v_dot2c_f32_bf16 v29, v198, v6
    v_dot2c_f32_bf16 v30, v199, v73
    v_dot2c_f32_bf16 v31, v199, v6
    s_add_u32 s54, s53, 86016
    buffer_load_dwordx4 v[196:199], v2, s[32:35], s54 offen offset:0 nt
    v_lshlrev_b32 v6, 16, v74
    s_waitcnt vmcnt(4)
    v_dot2c_f32_bf16 v24, v200, v74
    v_dot2c_f32_bf16 v25, v200, v6
    v_dot2c_f32_bf16 v26, v201, v74
    v_dot2c_f32_bf16 v27, v201, v6
    v_dot2c_f32_bf16 v28, v202, v74
    v_dot2c_f32_bf16 v29, v202, v6
    v_dot2c_f32_bf16 v30, v203, v74
    v_dot2c_f32_bf16 v31, v203, v6
    s_add_u32 s54, s53, 90112
    buffer_load_dwordx4 v[200:203], v2, s[32:35], s54 offen offset:0 nt
    v_lshlrev_b32 v6, 16, v75
    s_waitcnt vmcnt(4)
    v_dot2c_f32_bf16 v24, v204, v75
    v_dot2c_f32_bf16 v25, v204, v6
    v_dot2c_f32_bf16 v26, v205, v75
    v_dot2c_f32_bf16 v27, v205, v6
    v_dot2c_f32_bf16 v28, v206, v75
    v_dot2c_f32_bf16 v29, v206, v6
    v_dot2c_f32_bf16 v30, v207, v75
    v_dot2c_f32_bf16 v31, v207, v6
    s_add_u32 s54, s53, 94208
    buffer_load_dwordx4 v[204:207], v2, s[32:35], s54 offen offset:0 nt
    v_lshlrev_b32 v6, 16, v76
    s_waitcnt vmcnt(4)
    v_dot2c_f32_bf16 v24, v208, v76
    v_dot2c_f32_bf16 v25, v208, v6
    v_dot2c_f32_bf16 v26, v209, v76
    v_dot2c_f32_bf16 v27, v209, v6
    v_dot2c_f32_bf16 v28, v210, v76
    v_dot2c_f32_bf16 v29, v210, v6
    v_dot2c_f32_bf16 v30, v211, v76
    v_dot2c_f32_bf16 v31, v211, v6
    s_add_u32 s54, s53, 98304
    buffer_load_dwordx4 v[208:211], v2, s[32:35], s54 offen offset:0 nt
    v_lshlrev_b32 v6, 16, v77
    s_waitcnt vmcnt(4)
    v_dot2c_f32_bf16 v24, v212, v77
    v_dot2c_f32_bf16 v25, v212, v6
    v_dot2c_f32_bf16 v26, v213, v77
    v_dot2c_f32_bf16 v27, v213, v6
    v_dot2c_f32_bf16 v28, v214, v77
    v_dot2c_f32_bf16 v29, v214, v6
    v_dot2c_f32_bf16 v30, v215, v77
    v_dot2c_f32_bf16 v31, v215, v6
    s_add_u32 s54, s53, 102400
    buffer_load_dwordx4 v[212:215], v2, s[32:35], s54 offen offset:0 nt
    v_lshlrev_b32 v6, 16, v78
    s_waitcnt vmcnt(4)
    v_dot2c_f32_bf16 v24, v216, v78
    v_dot2c_f32_bf16 v25, v216, v6
    v_dot2c_f32_bf16 v26, v217, v78
    v_dot2c_f32_bf16 v27, v217, v6
    v_dot2c_f32_bf16 v28, v218, v78
    v_dot2c_f32_bf16 v29, v218, v6
    v_dot2c_f32_bf16 v30, v219, v78
    v_dot2c_f32_bf16 v31, v219, v6
    s_add_u32 s54, s53, 106496
    buffer_load_dwordx4 v[216:219], v2, s[32:35], s54 offen offset:0 nt
    v_lshlrev_b32 v6, 16, v79
    s_waitcnt vmcnt(4)
    v_dot2c_f32_bf16 v24, v220, v79
    v_dot2c_f32_bf16 v25, v220, v6
    v_dot2c_f32_bf16 v26, v221, v79
    v_dot2c_f32_bf16 v27, v221, v6
    v_dot2c_f32_bf16 v28, v222, v79
    v_dot2c_f32_bf16 v29, v222, v6
    v_dot2c_f32_bf16 v30, v223, v79
    v_dot2c_f32_bf16 v31, v223, v6
    s_add_u32 s54, s53, 110592
    buffer_load_dwordx4 v[220:223], v2, s[32:35], s54 offen offset:0 nt
    v_lshlrev_b32 v6, 16, v80
    s_waitcnt vmcnt(4)
    v_dot2c_f32_bf16 v24, v224, v80
    v_dot2c_f32_bf16 v25, v224, v6
    v_dot2c_f32_bf16 v26, v225, v80
    v_dot2c_f32_bf16 v27, v225, v6
    v_dot2c_f32_bf16 v28, v226, v80
    v_dot2c_f32_bf16 v29, v226, v6
    v_dot2c_f32_bf16 v30, v227, v80
    v_dot2c_f32_bf16 v31, v227, v6
    s_add_u32 s54, s53, 114688
    buffer_load_dwordx4 v[224:227], v2, s[32:35], s54 offen offset:0 nt
    v_lshlrev_b32 v6, 16, v81
    s_waitcnt vmcnt(4)
    v_dot2c_f32_bf16 v24, v228, v81
    v_dot2c_f32_bf16 v25, v228, v6
    v_dot2c_f32_bf16 v26, v229, v81
    v_dot2c_f32_bf16 v27, v229, v6
    v_dot2c_f32_bf16 v28, v230, v81
    v_dot2c_f32_bf16 v29, v230, v6
    v_dot2c_f32_bf16 v30, v231, v81
    v_dot2c_f32_bf16 v31, v231, v6
    s_add_u32 s54, s53, 118784
    buffer_load_dwordx4 v[228:231], v2, s[32:35], s54 offen offset:0 nt
    v_lshlrev_b32 v6, 16, v82
    s_waitcnt vmcnt(4)
    v_dot2c_f32_bf16 v24, v232, v82
    v_dot2c_f32_bf16 v25, v232, v6
    v_dot2c_f32_bf16 v26, v233, v82
    v_dot2c_f32_bf16 v27, v233, v6
    v_dot2c_f32_bf16 v28, v234, v82
    v_dot2c_f32_bf16 v29, v234, v6
    v_dot2c_f32_bf16 v30, v235, v82
    v_dot2c_f32_bf16 v31, v235, v6
    s_add_u32 s54, s53, 122880
    buffer_load_dwordx4 v[232:235], v2, s[32:35], s54 offen offset:0 nt
    v_lshlrev_b32 v6, 16, v83
    s_waitcnt vmcnt(4)
    v_dot2c_f32_bf16 v24, v236, v83
    v_dot2c_f32_bf16 v25, v236, v6
    v_dot2c_f32_bf16 v26, v237, v83
    v_dot2c_f32_bf16 v27, v237, v6
    v_dot2c_f32_bf16 v28, v238, v83
    v_dot2c_f32_bf16 v29, v238, v6
    v_dot2c_f32_bf16 v30, v239, v83
    v_dot2c_f32_bf16 v31, v239, v6
    s_add_u32 s54, s53, 126976
    buffer_load_dwordx4 v[236:239], v2, s[32:35], s54 offen offset:0 nt
    s_add_u32 s55, s55, 1
    v_cmp_lt_f32 vcc, 0.5, v43
    s_cbranch_vccnz L_vloop2
    s_cmp_lt_u32 s55, 3
    s_cbranch_scc1 L_vloop
L_vloop2:
    ds_read_b128 v[52:55], v9 offset:22528
    ds_read_b128 v[56:59], v9 offset:22544
    ds_read_b128 v[60:63], v9 offset:22560
    ds_read_b128 v[64:67], v9 offset:22576
    ds_read_b128 v[68:71], v9 offset:22592
    ds_read_b128 v[72:75], v9 offset:22608
    ds_read_b128 v[76:79], v9 offset:22624
    ds_read_b128 v[80:83], v9 offset:22640
    v_mov_b32 v6, 0
    ds_read_b32 v43, v6 offset:2704
    v_add_u32 v9, 128, v9
    s_add_u32 s53, s53, 131072
    s_waitcnt lgkmcnt(0)
    v_lshlrev_b32 v6, 16, v52
    s_waitcnt vmcnt(6)
    v_dot2c_f32_bf16 v24, v112, v52
    v_dot2c_f32_bf16 v25, v112, v6
    v_dot2c_f32_bf16 v26, v113, v52
    v_dot2c_f32_bf16 v27, v113, v6
    v_dot2c_f32_bf16 v28, v114, v52
    v_dot2c_f32_bf16 v29, v114, v6
    v_dot2c_f32_bf16 v30, v115, v52
    v_dot2c_f32_bf16 v31, v115, v6
    buffer_load_dwordx4 v[112:115], v2, s[32:35], s53 offen offset:0 nt
    v_lshlrev_b32 v6, 16, v53
    s_waitcnt vmcnt(6)
    v_dot2c_f32_bf16 v24, v116, v53
    v_dot2c_f32_bf16 v25, v116, v6
    v_dot2c_f32_bf16 v26, v117, v53
    v_dot2c_f32_bf16 v27, v117, v6
    v_dot2c_f32_bf16 v28, v118, v53
    v_dot2c_f32_bf16 v29, v118, v6
    v_dot2c_f32_bf16 v30, v119, v53
    v_dot2c_f32_bf16 v31, v119, v6
    s_add_u32 s54, s53, 4096
    buffer_load_dwordx4 v[116:119], v2, s[32:35], s54 offen offset:0 nt
    v_lshlrev_b32 v6, 16, v54
    s_waitcnt vmcnt(6)
    v_dot2c_f32_bf16 v24, v120, v54
    v_dot2c_f32_bf16 v25, v120, v6
    v_dot2c_f32_bf16 v26, v121, v54
    v_dot2c_f32_bf16 v27, v121, v6
    v_dot2c_f32_bf16 v28, v122, v54
    v_dot2c_f32_bf16 v29, v122, v6
    v_dot2c_f32_bf16 v30, v123, v54
    v_dot2c_f32_bf16 v31, v123, v6
    s_add_u32 s54, s53, 8192
    buffer_load_dwordx4 v[120:123], v2, s[32:35], s54 offen offset:0 nt
    v_lshlrev_b32 v6, 16, v55
    s_waitcnt vmcnt(6)
    v_dot2c_f32_bf16 v24, v124, v55
    v_dot2c_f32_bf16 v25, v124, v6
    v_dot2c_f32_bf16 v26, v125, v55
    v_dot2c_f32_bf16 v27, v125, v6
    v_dot2c_f32_bf16 v28, v126, v55
    v_dot2c_f32_bf16 v29, v126, v6
    v_dot2c_f32_bf16 v30, v127, v55
    v_dot2c_f32_bf16 v31, v127, v6
    s_add_u32 s54, s53, 12288
    buffer_load_dwordx4 v[124:127], v2, s[32:35], s54 offen offset:0 nt
    v_lshlrev_b32 v6, 16, v56
    s_waitcnt vmcnt(6)
    v_dot2c_f32_bf16 v24, v128, v56
    v_dot2c_f32_bf16 v25, v128, v6
    v_dot2c_f32_bf16 v26, v129, v56
    v_dot2c_f32_bf16 v27, v129, v6
    v_dot2c_f32_bf16 v28, v130, v56
    v_dot2c_f32_bf16 v29, v130, v6
    v_dot2c_f32_bf16 v30, v131, v56
    v_dot2c_f32_bf16 v31, v131, v6
    s_add_u32 s54, s53, 16384
    buffer_load_dwordx4 v[128:131], v2, s[32:35], s54 offen offset:0 nt
    v_lshlrev_b32 v6, 16, v57
    s_waitcnt vmcnt(6)
    v_dot2c_f32_bf16 v24, v132, v57
    v_dot2c_f32_bf16 v25, v132, v6
    v_dot2c_f32_bf16 v26, v133, v57
    v_dot2c_f32_bf16 v27, v133, v6
    v_dot2c_f32_bf16 v28, v134, v57
    v_dot2c_f32_bf16 v29, v134, v6
    v_dot2c_f32_bf16 v30, v135, v57
    v_dot2c_f32_bf16 v31, v135, v6
    s_add_u32 s54, s53, 20480
    buffer_load_dwordx4 v[132:135], v2, s[32:35], s54 offen offset:0 nt
    v_lshlrev_b32 v6, 16, v58
    s_waitcnt vmcnt(6)
    v_dot2c_f32_bf16 v24, v136, v58
    v_dot2c_f32_bf16 v25, v136, v6
    v_dot2c_f32_bf16 v26, v137, v58
    v_dot2c_f32_bf16 v27, v137, v6
    v_dot2c_f32_bf16 v28, v138, v58
    v_dot2c_f32_bf16 v29, v138, v6
    v_dot2c_f32_bf16 v30, v139, v58
    v_dot2c_f32_bf16 v31, v139, v6
    s_add_u32 s54, s53, 24576
    buffer_load_dwordx4 v[136:139], v2, s[32:35], s54 offen offset:0 nt
    v_lshlrev_b32 v6, 16, v59
    s_waitcnt vmcnt(6)
    v_dot2c_f32_bf16 v24, v140, v59
    v_dot2c_f32_bf16 v25, v140, v6
    v_dot2c_f32_bf16 v26, v141, v59
    v_dot2c_f32_bf16 v27, v141, v6
    v_dot2c_f32_bf16 v28, v142, v59
    v_dot2c_f32_bf16 v29, v142, v6
    v_dot2c_f32_bf16 v30, v143, v59
    v_dot2c_f32_bf16 v31, v143, v6
    s_add_u32 s54, s53, 28672
    buffer_load_dwordx4 v[140:143], v2, s[32:35], s54 offen offset:0 nt
    v_lshlrev_b32 v6, 16, v60
    s_waitcnt vmcnt(6)
    v_dot2c_f32_bf16 v24, v144, v60
    v_dot2c_f32_bf16 v25, v144, v6
    v_dot2c_f32_bf16 v26, v145, v60
    v_dot2c_f32_bf16 v27, v145, v6
    v_dot2c_f32_bf16 v28, v146, v60
    v_dot2c_f32_bf16 v29, v146, v6
    v_dot2c_f32_bf16 v30, v147, v60
    v_dot2c_f32_bf16 v31, v147, v6
    s_add_u32 s54, s53, 32768
    buffer_load_dwordx4 v[144:147], v2, s[32:35], s54 offen offset:0 nt
    v_lshlrev_b32 v6, 16, v61
    s_waitcnt vmcnt(6)
    v_dot2c_f32_bf16 v24, v148, v61
    v_dot2c_f32_bf16 v25, v148, v6
    v_dot2c_f32_bf16 v26, v149, v61
    v_dot2c_f32_bf16 v27, v149, v6
    v_dot2c_f32_bf16 v28, v150, v61
    v_dot2c_f32_bf16 v29, v150, v6
    v_dot2c_f32_bf16 v30, v151, v61
    v_dot2c_f32_bf16 v31, v151, v6
    s_add_u32 s54, s53, 36864
    buffer_load_dwordx4 v[148:151], v2, s[32:35], s54 offen offset:0 nt
    v_lshlrev_b32 v6, 16, v62
    s_waitcnt vmcnt(6)
    v_dot2c_f32_bf16 v24, v152, v62
    v_dot2c_f32_bf16 v25, v152, v6
    v_dot2c_f32_bf16 v26, v153, v62
    v_dot2c_f32_bf16 v27, v153, v6
    v_dot2c_f32_bf16 v28, v154, v62
    v_dot2c_f32_bf16 v29, v154, v6
    v_dot2c_f32_bf16 v30, v155, v62
    v_dot2c_f32_bf16 v31, v155, v6
    s_add_u32 s54, s53, 40960
    buffer_load_dwordx4 v[152:155], v2, s[32:35], s54 offen offset:0 nt
    v_lshlrev_b32 v6, 16, v63
    s_waitcnt vmcnt(6)
    v_dot2c_f32_bf16 v24, v156, v63
    v_dot2c_f32_bf16 v25, v156, v6
    v_dot2c_f32_bf16 v26, v157, v63
    v_dot2c_f32_bf16 v27, v157, v6
    v_dot2c_f32_bf16 v28, v158, v63
    v_dot2c_f32_bf16 v29, v158, v6
    v_dot2c_f32_bf16 v30, v159, v63
    v_dot2c_f32_bf16 v31, v159, v6
    s_add_u32 s54, s53, 45056
    buffer_load_dwordx4 v[156:159], v2, s[32:35], s54 offen offset:0 nt
    v_lshlrev_b32 v6, 16, v64
    s_waitcnt vmcnt(6)
    v_dot2c_f32_bf16 v24, v160, v64
    v_dot2c_f32_bf16 v25, v160, v6
    v_dot2c_f32_bf16 v26, v161, v64
    v_dot2c_f32_bf16 v27, v161, v6
    v_dot2c_f32_bf16 v28, v162, v64
    v_dot2c_f32_bf16 v29, v162, v6
    v_dot2c_f32_bf16 v30, v163, v64
    v_dot2c_f32_bf16 v31, v163, v6
    s_add_u32 s54, s53, 49152
    buffer_load_dwordx4 v[160:163], v2, s[32:35], s54 offen offset:0 nt
    v_lshlrev_b32 v6, 16, v65
    s_waitcnt vmcnt(6)
    v_dot2c_f32_bf16 v24, v164, v65
    v_dot2c_f32_bf16 v25, v164, v6
    v_dot2c_f32_bf16 v26, v165, v65
    v_dot2c_f32_bf16 v27, v165, v6
    v_dot2c_f32_bf16 v28, v166, v65
    v_dot2c_f32_bf16 v29, v166, v6
    v_dot2c_f32_bf16 v30, v167, v65
    v_dot2c_f32_bf16 v31, v167, v6
    s_add_u32 s54, s53, 53248
    buffer_load_dwordx4 v[164:167], v2, s[32:35], s54 offen offset:0 nt
    v_lshlrev_b32 v6, 16, v66
    s_waitcnt vmcnt(6)
    v_dot2c_f32_bf16 v24, v168, v66
    v_dot2c_f32_bf16 v25, v168, v6
    v_dot2c_f32_bf16 v26, v169, v66
    v_dot2c_f32_bf16 v27, v169, v6
    v_dot2c_f32_bf16 v28, v170, v66
    v_dot2c_f32_bf16 v29, v170, v6
    v_dot2c_f32_bf16 v30, v171, v66
    v_dot2c_f32_bf16 v31, v171, v6
    s_add_u32 s54, s53, 57344
    buffer_load_dwordx4 v[168:171], v2, s[32:35], s54 offen offset:0 nt
    v_lshlrev_b32 v6, 16, v67
    s_waitcnt vmcnt(6)
    v_dot2c_f32_bf16 v24, v172, v67
    v_dot2c_f32_bf16 v25, v172, v6
    v_dot2c_f32_bf16 v26, v173, v67
    v_dot2c_f32_bf16 v27, v173, v6
    v_dot2c_f32_bf16 v28, v174, v67
    v_dot2c_f32_bf16 v29, v174, v6
    v_dot2c_f32_bf16 v30, v175, v67
    v_dot2c_f32_bf16 v31, v175, v6
    s_add_u32 s54, s53, 61440
    buffer_load_dwordx4 v[172:175], v2, s[32:35], s54 offen offset:0 nt
    v_lshlrev_b32 v6, 16, v68
    s_waitcnt vmcnt(6)
    v_dot2c_f32_bf16 v24, v176, v68
    v_dot2c_f32_bf16 v25, v176, v6
    v_dot2c_f32_bf16 v26, v177, v68
    v_dot2c_f32_bf16 v27, v177, v6
    v_dot2c_f32_bf16 v28, v178, v68
    v_dot2c_f32_bf16 v29, v178, v6
    v_dot2c_f32_bf16 v30, v179, v68
    v_dot2c_f32_bf16 v31, v179, v6
    s_add_u32 s54, s53, 65536
    buffer_load_dwordx4 v[176:179], v2, s[32:35], s54 offen offset:0 nt
    v_lshlrev_b32 v6, 16, v69
    s_waitcnt vmcnt(6)
    v_dot2c_f32_bf16 v24, v180, v69
    v_dot2c_f32_bf16 v25, v180, v6
    v_dot2c_f32_bf16 v26, v181, v69
    v_dot2c_f32_bf16 v27, v181, v6
    v_dot2c_f32_bf16 v28, v182, v69
    v_dot2c_f32_bf16 v29, v182, v6
    v_dot2c_f32_bf16 v30, v183, v69
    v_dot2c_f32_bf16 v31, v183, v6
    s_add_u32 s54, s53, 69632
    buffer_load_dwordx4 v[180:183], v2, s[32:35], s54 offen offset:0 nt
    v_lshlrev_b32 v6, 16, v70
    s_waitcnt vmcnt(6)
    v_dot2c_f32_bf16 v24, v184, v70
    v_dot2c_f32_bf16 v25, v184, v6
    v_dot2c_f32_bf16 v26, v185, v70
    v_dot2c_f32_bf16 v27, v185, v6
    v_dot2c_f32_bf16 v28, v186, v70
    v_dot2c_f32_bf16 v29, v186, v6
    v_dot2c_f32_bf16 v30, v187, v70
    v_dot2c_f32_bf16 v31, v187, v6
    s_add_u32 s54, s53, 73728
    buffer_load_dwordx4 v[184:187], v2, s[32:35], s54 offen offset:0 nt
    v_lshlrev_b32 v6, 16, v71
    s_waitcnt vmcnt(6)
    v_dot2c_f32_bf16 v24, v188, v71
    v_dot2c_f32_bf16 v25, v188, v6
    v_dot2c_f32_bf16 v26, v189, v71
    v_dot2c_f32_bf16 v27, v189, v6
    v_dot2c_f32_bf16 v28, v190, v71
    v_dot2c_f32_bf16 v29, v190, v6
    v_dot2c_f32_bf16 v30, v191, v71
    v_dot2c_f32_bf16 v31, v191, v6
    s_add_u32 s54, s53, 77824
    buffer_load_dwordx4 v[188:191], v2, s[32:35], s54 offen offset:0 nt
    v_lshlrev_b32 v6, 16, v72
    s_waitcnt vmcnt(6)
    v_dot2c_f32_bf16 v24, v192, v72
    v_dot2c_f32_bf16 v25, v192, v6
    v_dot2c_f32_bf16 v26, v193, v72
    v_dot2c_f32_bf16 v27, v193, v6
    v_dot2c_f32_bf16 v28, v194, v72
    v_dot2c_f32_bf16 v29, v194, v6
    v_dot2c_f32_bf16 v30, v195, v72
    v_dot2c_f32_bf16 v31, v195, v6
    s_add_u32 s54, s53, 81920
    buffer_load_dwordx4 v[192:195], v2, s[32:35], s54 offen offset:0 nt
    v_lshlrev_b32 v6, 16, v73
    s_waitcnt vmcnt(6)
    v_dot2c_f32_bf16 v24, v196, v73
    v_dot2c_f32_bf16 v25, v196, v6
    v_dot2c_f32_bf16 v26, v197, v73
    v_dot2c_f32_bf16 v27, v197, v6
    v_dot2c_f32_bf16 v28, v198, v73
    v_dot2c_f32_bf16 v29, v198, v6
    v_dot2c_f32_bf16 v30, v199, v73
    v_dot2c_f32_bf16 v31, v199, v6
    s_add_u32 s54, s53, 86016
    buffer_load_dwordx4 v[196:199], v2, s[32:35], s54 offen offset:0 nt
    v_lshlrev_b32 v6, 16, v74
    s_waitcnt vmcnt(6)
    v_dot2c_f32_bf16 v24, v200, v74
    v_dot2c_f32_bf16 v25, v200, v6
    v_dot2c_f32_bf16 v26, v201, v74
    v_dot2c_f32_bf16 v27, v201, v6
    v_dot2c_f32_bf16 v28, v202, v74
    v_dot2c_f32_bf16 v29, v202, v6
    v_dot2c_f32_bf16 v30, v203, v74
    v_dot2c_f32_bf16 v31, v203, v6
    s_add_u32 s54, s53, 90112
    buffer_load_dwordx4 v[200:203], v2, s[32:35], s54 offen offset:0 nt
    v_lshlrev_b32 v6, 16, v75
    s_waitcnt vmcnt(6)
    v_dot2c_f32_bf16 v24, v204, v75
    v_dot2c_f32_bf16 v25, v204, v6
    v_dot2c_f32_bf16 v26, v205, v75
    v_dot2c_f32_bf16 v27, v205, v6
    v_dot2c_f32_bf16 v28, v206, v75
    v_dot2c_f32_bf16 v29, v206, v6
    v_dot2c_f32_bf16 v30, v207, v75
    v_dot2c_f32_bf16 v31, v207, v6
    s_add_u32 s54, s53, 94208
    buffer_load_dwordx4 v[204:207], v2, s[32:35], s54 offen offset:0 nt
    v_lshlrev_b32 v6, 16, v76
    s_waitcnt vmcnt(6)
    v_dot2c_f32_bf16 v24, v208, v76
    v_dot2c_f32_bf16 v25, v208, v6
    v_dot2c_f32_bf16 v26, v209, v76
    v_dot2c_f32_bf16 v27, v209, v6
    v_dot2c_f32_bf16 v28, v210, v76
    v_dot2c_f32_bf16 v29, v210, v6
    v_dot2c_f32_bf16 v30, v211, v76
    v_dot2c_f32_bf16 v31, v211, v6
    s_add_u32 s54, s53, 98304
    buffer_load_dwordx4 v[208:211], v2, s[32:35], s54 offen offset:0 nt
    v_lshlrev_b32 v6, 16, v77
    s_waitcnt vmcnt(6)
    v_dot2c_f32_bf16 v24, v212, v77
    v_dot2c_f32_bf16 v25, v212, v6
    v_dot2c_f32_bf16 v26, v213, v77
    v_dot2c_f32_bf16 v27, v213, v6
    v_dot2c_f32_bf16 v28, v214, v77
    v_dot2c_f32_bf16 v29, v214, v6
    v_dot2c_f32_bf16 v30, v215, v77
    v_dot2c_f32_bf16 v31, v215, v6
    s_add_u32 s54, s53, 102400
    buffer_load_dwordx4 v[212:215], v2, s[32:35], s54 offen offset:0 nt
    v_lshlrev_b32 v6, 16, v78
    s_waitcnt vmcnt(6)
    v_dot2c_f32_bf16 v24, v216, v78
    v_dot2c_f32_bf16 v25, v216, v6
    v_dot2c_f32_bf16 v26, v217, v78
    v_dot2c_f32_bf16 v27, v217, v6
    v_dot2c_f32_bf16 v28, v218, v78
    v_dot2c_f32_bf16 v29, v218, v6
    v_dot2c_f32_bf16 v30, v219, v78
    v_dot2c_f32_bf16 v31, v219, v6
    s_add_u32 s54, s53, 106496
    buffer_load_dwordx4 v[216:219], v2, s[32:35], s54 offen offset:0 nt
    v_lshlrev_b32 v6, 16, v79
    s_waitcnt vmcnt(6)
    v_dot2c_f32_bf16 v24, v220, v79
    v_dot2c_f32_bf16 v25, v220, v6
    v_dot2c_f32_bf16 v26, v221, v79
    v_dot2c_f32_bf16 v27, v221, v6
    v_dot2c_f32_bf16 v28, v222, v79
    v_dot2c_f32_bf16 v29, v222, v6
    v_dot2c_f32_bf16 v30, v223, v79
    v_dot2c_f32_bf16 v31, v223, v6
    s_add_u32 s54, s53, 110592
    buffer_load_dwordx4 v[220:223], v2, s[32:35], s54 offen offset:0 nt
    v_lshlrev_b32 v6, 16, v80
    s_waitcnt vmcnt(6)
    v_dot2c_f32_bf16 v24, v224, v80
    v_dot2c_f32_bf16 v25, v224, v6
    v_dot2c_f32_bf16 v26, v225, v80
    v_dot2c_f32_bf16 v27, v225, v6
    v_dot2c_f32_bf16 v28, v226, v80
    v_dot2c_f32_bf16 v29, v226, v6
    v_dot2c_f32_bf16 v30, v227, v80
    v_dot2c_f32_bf16 v31, v227, v6
    s_add_u32 s54, s53, 114688
    buffer_load_dwordx4 v[224:227], v2, s[32:35], s54 offen offset:0 nt
    v_lshlrev_b32 v6, 16, v81
    s_waitcnt vmcnt(6)
    v_dot2c_f32_bf16 v24, v228, v81
    v_dot2c_f32_bf16 v25, v228, v6
    v_dot2c_f32_bf16 v26, v229, v81
    v_dot2c_f32_bf16 v27, v229, v6
    v_dot2c_f32_bf16 v28, v230, v81
    v_dot2c_f32_bf16 v29, v230, v6
    v_dot2c_f32_bf16 v30, v231, v81
    v_dot2c_f32_bf16 v31, v231, v6
    s_add_u32 s54, s53, 118784
    buffer_load_dwordx4 v[228:231], v2, s[32:35], s54 offen offset:0 nt
    v_lshlrev_b32 v6, 16, v82
    s_waitcnt vmcnt(6)
    v_dot2c_f32_bf16 v24, v232, v82
    v_dot2c_f32_bf16 v25, v232, v6
    v_dot2c_f32_bf16 v26, v233, v82
    v_dot2c_f32_bf16 v27, v233, v6
    v_dot2c_f32_bf16 v28, v234, v82
    v_dot2c_f32_bf16 v29, v234, v6
    v_dot2c_f32_bf16 v30, v235, v82
    v_dot2c_f32_bf16 v31, v235, v6
    s_add_u32 s54, s53, 122880
    buffer_load_dwordx4 v[232:235], v2, s[32:35], s54 offen offset:0 nt
    v_lshlrev_b32 v6, 16, v83
    s_waitcnt vmcnt(6)
    v_dot2c_f32_bf16 v24, v236, v83
    v_dot2c_f32_bf16 v25, v236, v6
    v_dot2c_f32_bf16 v26, v237, v83
    v_dot2c_f32_bf16 v27, v237, v6
    v_dot2c_f32_bf16 v28, v238, v83
    v_dot2c_f32_bf16 v29, v238, v6
    v_dot2c_f32_bf16 v30, v239, v83
    v_dot2c_f32_bf16 v31, v239, v6
    s_add_u32 s54, s53, 126976
    buffer_load_dwordx4 v[236:239], v2, s[32:35], s54 offen offset:0 nt
    s_add_u32 s55, s55, 1
    s_cmp_lt_u32 s55, 7
    s_cbranch_scc1 L_vloop2
    v_lshlrev_b32 v5, 5, v10
    v_lshl_add_u32 v5, v11, 4, v5
    s_lshl_b32 s54, s52, 10
    v_add_u32 v5, s54, v5
    ds_read_b128 v[52:55], v9 offset:22528
    ds_read_b128 v[56:59], v9 offset:22544
    ds_read_b128 v[60:63], v9 offset:22560
    ds_read_b128 v[64:67], v9 offset:22576
    ds_read_b128 v[68:71], v9 offset:22592
    ds_read_b128 v[72:75], v9 offset:22608
    ds_read_b128 v[76:79], v9 offset:22624
    ds_read_b128 v[80:83], v9 offset:22640
    s_lshl_b32 s54, s52, 2
    v_mov_b32 v4, s54
    ds_read_b32 v42, v4 offset:2688
    s_waitcnt lgkmcnt(0)
    v_lshlrev_b32 v6, 16, v52
    s_waitcnt vmcnt(31)
    v_dot2c_f32_bf16 v24, v112, v52
    v_dot2c_f32_bf16 v25, v112, v6
    v_dot2c_f32_bf16 v26, v113, v52
    v_dot2c_f32_bf16 v27, v113, v6
    v_dot2c_f32_bf16 v28, v114, v52
    v_dot2c_f32_bf16 v29, v114, v6
    v_dot2c_f32_bf16 v30, v115, v52
    v_dot2c_f32_bf16 v31, v115, v6
    v_lshlrev_b32 v6, 16, v53
    s_waitcnt vmcnt(30)
    v_dot2c_f32_bf16 v24, v116, v53
    v_dot2c_f32_bf16 v25, v116, v6
    v_dot2c_f32_bf16 v26, v117, v53
    v_dot2c_f32_bf16 v27, v117, v6
    v_dot2c_f32_bf16 v28, v118, v53
    v_dot2c_f32_bf16 v29, v118, v6
    v_dot2c_f32_bf16 v30, v119, v53
    v_dot2c_f32_bf16 v31, v119, v6
    v_lshlrev_b32 v6, 16, v54
    s_waitcnt vmcnt(29)
    v_dot2c_f32_bf16 v24, v120, v54
    v_dot2c_f32_bf16 v25, v120, v6
    v_dot2c_f32_bf16 v26, v121, v54
    v_dot2c_f32_bf16 v27, v121, v6
    v_dot2c_f32_bf16 v28, v122, v54
    v_dot2c_f32_bf16 v29, v122, v6
    v_dot2c_f32_bf16 v30, v123, v54
    v_dot2c_f32_bf16 v31, v123, v6
    v_lshlrev_b32 v6, 16, v55
    s_waitcnt vmcnt(28)
    v_dot2c_f32_bf16 v24, v124, v55
    v_dot2c_f32_bf16 v25, v124, v6
    v_dot2c_f32_bf16 v26, v125, v55
    v_dot2c_f32_bf16 v27, v125, v6
    v_dot2c_f32_bf16 v28, v126, v55
    v_dot2c_f32_bf16 v29, v126, v6
    v_dot2c_f32_bf16 v30, v127, v55
    v_dot2c_f32_bf16 v31, v127, v6
    v_lshlrev_b32 v6, 16, v56
    s_waitcnt vmcnt(27)
    v_dot2c_f32_bf16 v24, v128, v56
    v_dot2c_f32_bf16 v25, v128, v6
    v_dot2c_f32_bf16 v26, v129, v56
    v_dot2c_f32_bf16 v27, v129, v6
    v_dot2c_f32_bf16 v28, v130, v56
    v_dot2c_f32_bf16 v29, v130, v6
    v_dot2c_f32_bf16 v30, v131, v56
    v_dot2c_f32_bf16 v31, v131, v6
    v_lshlrev_b32 v6, 16, v57
    s_waitcnt vmcnt(26)
    v_dot2c_f32_bf16 v24, v132, v57
    v_dot2c_f32_bf16 v25, v132, v6
    v_dot2c_f32_bf16 v26, v133, v57
    v_dot2c_f32_bf16 v27, v133, v6
    v_dot2c_f32_bf16 v28, v134, v57
    v_dot2c_f32_bf16 v29, v134, v6
    v_dot2c_f32_bf16 v30, v135, v57
    v_dot2c_f32_bf16 v31, v135, v6
    v_lshlrev_b32 v6, 16, v58
    s_waitcnt vmcnt(25)
    v_dot2c_f32_bf16 v24, v136, v58
    v_dot2c_f32_bf16 v25, v136, v6
    v_dot2c_f32_bf16 v26, v137, v58
    v_dot2c_f32_bf16 v27, v137, v6
    v_dot2c_f32_bf16 v28, v138, v58
    v_dot2c_f32_bf16 v29, v138, v6
    v_dot2c_f32_bf16 v30, v139, v58
    v_dot2c_f32_bf16 v31, v139, v6
    v_lshlrev_b32 v6, 16, v59
    s_waitcnt vmcnt(24)
    v_dot2c_f32_bf16 v24, v140, v59
    v_dot2c_f32_bf16 v25, v140, v6
    v_dot2c_f32_bf16 v26, v141, v59
    v_dot2c_f32_bf16 v27, v141, v6
    v_dot2c_f32_bf16 v28, v142, v59
    v_dot2c_f32_bf16 v29, v142, v6
    v_dot2c_f32_bf16 v30, v143, v59
    v_dot2c_f32_bf16 v31, v143, v6
    v_lshlrev_b32 v6, 16, v60
    s_waitcnt vmcnt(23)
    v_dot2c_f32_bf16 v24, v144, v60
    v_dot2c_f32_bf16 v25, v144, v6
    v_dot2c_f32_bf16 v26, v145, v60
    v_dot2c_f32_bf16 v27, v145, v6
    v_dot2c_f32_bf16 v28, v146, v60
    v_dot2c_f32_bf16 v29, v146, v6
    v_dot2c_f32_bf16 v30, v147, v60
    v_dot2c_f32_bf16 v31, v147, v6
    v_lshlrev_b32 v6, 16, v61
    s_waitcnt vmcnt(22)
    v_dot2c_f32_bf16 v24, v148, v61
    v_dot2c_f32_bf16 v25, v148, v6
    v_dot2c_f32_bf16 v26, v149, v61
    v_dot2c_f32_bf16 v27, v149, v6
    v_dot2c_f32_bf16 v28, v150, v61
    v_dot2c_f32_bf16 v29, v150, v6
    v_dot2c_f32_bf16 v30, v151, v61
    v_dot2c_f32_bf16 v31, v151, v6
    v_lshlrev_b32 v6, 16, v62
    s_waitcnt vmcnt(21)
    v_dot2c_f32_bf16 v24, v152, v62
    v_dot2c_f32_bf16 v25, v152, v6
    v_dot2c_f32_bf16 v26, v153, v62
    v_dot2c_f32_bf16 v27, v153, v6
    v_dot2c_f32_bf16 v28, v154, v62
    v_dot2c_f32_bf16 v29, v154, v6
    v_dot2c_f32_bf16 v30, v155, v62
    v_dot2c_f32_bf16 v31, v155, v6
    v_lshlrev_b32 v6, 16, v63
    s_waitcnt vmcnt(20)
    v_dot2c_f32_bf16 v24, v156, v63
    v_dot2c_f32_bf16 v25, v156, v6
    v_dot2c_f32_bf16 v26, v157, v63
    v_dot2c_f32_bf16 v27, v157, v6
    v_dot2c_f32_bf16 v28, v158, v63
    v_dot2c_f32_bf16 v29, v158, v6
    v_dot2c_f32_bf16 v30, v159, v63
    v_dot2c_f32_bf16 v31, v159, v6
    v_lshlrev_b32 v6, 16, v64
    s_waitcnt vmcnt(19)
    v_dot2c_f32_bf16 v24, v160, v64
    v_dot2c_f32_bf16 v25, v160, v6
    v_dot2c_f32_bf16 v26, v161, v64
    v_dot2c_f32_bf16 v27, v161, v6
    v_dot2c_f32_bf16 v28, v162, v64
    v_dot2c_f32_bf16 v29, v162, v6
    v_dot2c_f32_bf16 v30, v163, v64
    v_dot2c_f32_bf16 v31, v163, v6
    v_lshlrev_b32 v6, 16, v65
    s_waitcnt vmcnt(18)
    v_dot2c_f32_bf16 v24, v164, v65
    v_dot2c_f32_bf16 v25, v164, v6
    v_dot2c_f32_bf16 v26, v165, v65
    v_dot2c_f32_bf16 v27, v165, v6
    v_dot2c_f32_bf16 v28, v166, v65
    v_dot2c_f32_bf16 v29, v166, v6
    v_dot2c_f32_bf16 v30, v167, v65
    v_dot2c_f32_bf16 v31, v167, v6
    v_lshlrev_b32 v6, 16, v66
    s_waitcnt vmcnt(17)
    v_dot2c_f32_bf16 v24, v168, v66
    v_dot2c_f32_bf16 v25, v168, v6
    v_dot2c_f32_bf16 v26, v169, v66
    v_dot2c_f32_bf16 v27, v169, v6
    v_dot2c_f32_bf16 v28, v170, v66
    v_dot2c_f32_bf16 v29, v170, v6
    v_dot2c_f32_bf16 v30, v171, v66
    v_dot2c_f32_bf16 v31, v171, v6
    v_lshlrev_b32 v6, 16, v67
    s_waitcnt vmcnt(16)
    v_dot2c_f32_bf16 v24, v172, v67
    v_dot2c_f32_bf16 v25, v172, v6
    v_dot2c_f32_bf16 v26, v173, v67
    v_dot2c_f32_bf16 v27, v173, v6
    v_dot2c_f32_bf16 v28, v174, v67
    v_dot2c_f32_bf16 v29, v174, v6
    v_dot2c_f32_bf16 v30, v175, v67
    v_dot2c_f32_bf16 v31, v175, v6
    v_lshlrev_b32 v6, 16, v68
    s_waitcnt vmcnt(15)
    v_dot2c_f32_bf16 v24, v176, v68
    v_dot2c_f32_bf16 v25, v176, v6
    v_dot2c_f32_bf16 v26, v177, v68
    v_dot2c_f32_bf16 v27, v177, v6
    v_dot2c_f32_bf16 v28, v178, v68
    v_dot2c_f32_bf16 v29, v178, v6
    v_dot2c_f32_bf16 v30, v179, v68
    v_dot2c_f32_bf16 v31, v179, v6
    v_lshlrev_b32 v6, 16, v69
    s_waitcnt vmcnt(14)
    v_dot2c_f32_bf16 v24, v180, v69
    v_dot2c_f32_bf16 v25, v180, v6
    v_dot2c_f32_bf16 v26, v181, v69
    v_dot2c_f32_bf16 v27, v181, v6
    v_dot2c_f32_bf16 v28, v182, v69
    v_dot2c_f32_bf16 v29, v182, v6
    v_dot2c_f32_bf16 v30, v183, v69
    v_dot2c_f32_bf16 v31, v183, v6
    v_lshlrev_b32 v6, 16, v70
    s_waitcnt vmcnt(13)
    v_dot2c_f32_bf16 v24, v184, v70
    v_dot2c_f32_bf16 v25, v184, v6
    v_dot2c_f32_bf16 v26, v185, v70
    v_dot2c_f32_bf16 v27, v185, v6
    v_dot2c_f32_bf16 v28, v186, v70
    v_dot2c_f32_bf16 v29, v186, v6
    v_dot2c_f32_bf16 v30, v187, v70
    v_dot2c_f32_bf16 v31, v187, v6
    v_lshlrev_b32 v6, 16, v71
    s_waitcnt vmcnt(12)
    v_dot2c_f32_bf16 v24, v188, v71
    v_dot2c_f32_bf16 v25, v188, v6
    v_dot2c_f32_bf16 v26, v189, v71
    v_dot2c_f32_bf16 v27, v189, v6
    v_dot2c_f32_bf16 v28, v190, v71
    v_dot2c_f32_bf16 v29, v190, v6
    v_dot2c_f32_bf16 v30, v191, v71
    v_dot2c_f32_bf16 v31, v191, v6
    v_lshlrev_b32 v6, 16, v72
    s_waitcnt vmcnt(11)
    v_dot2c_f32_bf16 v24, v192, v72
    v_dot2c_f32_bf16 v25, v192, v6
    v_dot2c_f32_bf16 v26, v193, v72
    v_dot2c_f32_bf16 v27, v193, v6
    v_dot2c_f32_bf16 v28, v194, v72
    v_dot2c_f32_bf16 v29, v194, v6
    v_dot2c_f32_bf16 v30, v195, v72
    v_dot2c_f32_bf16 v31, v195, v6
    v_lshlrev_b32 v6, 16, v73
    s_waitcnt vmcnt(10)
    v_dot2c_f32_bf16 v24, v196, v73
    v_dot2c_f32_bf16 v25, v196, v6
    v_dot2c_f32_bf16 v26, v197, v73
    v_dot2c_f32_bf16 v27, v197, v6
    v_dot2c_f32_bf16 v28, v198, v73
    v_dot2c_f32_bf16 v29, v198, v6
    v_dot2c_f32_bf16 v30, v199, v73
    v_dot2c_f32_bf16 v31, v199, v6
    v_lshlrev_b32 v6, 16, v74
    s_waitcnt vmcnt(9)
    v_dot2c_f32_bf16 v24, v200, v74
    v_dot2c_f32_bf16 v25, v200, v6
    v_dot2c_f32_bf16 v26, v201, v74
    v_dot2c_f32_bf16 v27, v201, v6
    v_dot2c_f32_bf16 v28, v202, v74
    v_dot2c_f32_bf16 v29, v202, v6
    v_dot2c_f32_bf16 v30, v203, v74
    v_dot2c_f32_bf16 v31, v203, v6
    v_lshlrev_b32 v6, 16, v75
    s_waitcnt vmcnt(8)
    v_dot2c_f32_bf16 v24, v204, v75
    v_dot2c_f32_bf16 v25, v204, v6
    v_dot2c_f32_bf16 v26, v205, v75
    v_dot2c_f32_bf16 v27, v205, v6
    v_dot2c_f32_bf16 v28, v206, v75
    v_dot2c_f32_bf16 v29, v206, v6
    v_dot2c_f32_bf16 v30, v207, v75
    v_dot2c_f32_bf16 v31, v207, v6
    v_lshlrev_b32 v6, 16, v76
    s_waitcnt vmcnt(7)
    v_dot2c_f32_bf16 v24, v208, v76
    v_dot2c_f32_bf16 v25, v208, v6
    v_dot2c_f32_bf16 v26, v209, v76
    v_dot2c_f32_bf16 v27, v209, v6
    v_dot2c_f32_bf16 v28, v210, v76
    v_dot2c_f32_bf16 v29, v210, v6
    v_dot2c_f32_bf16 v30, v211, v76
    v_dot2c_f32_bf16 v31, v211, v6
    v_lshlrev_b32 v6, 16, v77
    s_waitcnt vmcnt(6)
    v_dot2c_f32_bf16 v24, v212, v77
    v_dot2c_f32_bf16 v25, v212, v6
    v_dot2c_f32_bf16 v26, v213, v77
    v_dot2c_f32_bf16 v27, v213, v6
    v_dot2c_f32_bf16 v28, v214, v77
    v_dot2c_f32_bf16 v29, v214, v6
    v_dot2c_f32_bf16 v30, v215, v77
    v_dot2c_f32_bf16 v31, v215, v6
    v_lshlrev_b32 v6, 16, v78
    s_waitcnt vmcnt(5)
    v_dot2c_f32_bf16 v24, v216, v78
    v_dot2c_f32_bf16 v25, v216, v6
    v_dot2c_f32_bf16 v26, v217, v78
    v_dot2c_f32_bf16 v27, v217, v6
    v_dot2c_f32_bf16 v28, v218, v78
    v_dot2c_f32_bf16 v29, v218, v6
    v_dot2c_f32_bf16 v30, v219, v78
    v_dot2c_f32_bf16 v31, v219, v6
    v_lshlrev_b32 v6, 16, v79
    s_waitcnt vmcnt(4)
    v_dot2c_f32_bf16 v24, v220, v79
    v_dot2c_f32_bf16 v25, v220, v6
    v_dot2c_f32_bf16 v26, v221, v79
    v_dot2c_f32_bf16 v27, v221, v6
    v_dot2c_f32_bf16 v28, v222, v79
    v_dot2c_f32_bf16 v29, v222, v6
    v_dot2c_f32_bf16 v30, v223, v79
    v_dot2c_f32_bf16 v31, v223, v6
    v_lshlrev_b32 v6, 16, v80
    s_waitcnt vmcnt(3)
    v_dot2c_f32_bf16 v24, v224, v80
    v_dot2c_f32_bf16 v25, v224, v6
    v_dot2c_f32_bf16 v26, v225, v80
    v_dot2c_f32_bf16 v27, v225, v6
    v_dot2c_f32_bf16 v28, v226, v80
    v_dot2c_f32_bf16 v29, v226, v6
    v_dot2c_f32_bf16 v30, v227, v80
    v_dot2c_f32_bf16 v31, v227, v6
    v_lshlrev_b32 v6, 16, v81
    s_waitcnt vmcnt(2)
    v_dot2c_f32_bf16 v24, v228, v81
    v_dot2c_f32_bf16 v25, v228, v6
    v_dot2c_f32_bf16 v26, v229, v81
    v_dot2c_f32_bf16 v27, v229, v6
    v_dot2c_f32_bf16 v28, v230, v81
    v_dot2c_f32_bf16 v29, v230, v6
    v_dot2c_f32_bf16 v30, v231, v81
    v_dot2c_f32_bf16 v31, v231, v6
    v_lshlrev_b32 v6, 16, v82
    s_waitcnt vmcnt(1)
    v_dot2c_f32_bf16 v24, v232, v82
    v_dot2c_f32_bf16 v25, v232, v6
    v_dot2c_f32_bf16 v26, v233, v82
    v_dot2c_f32_bf16 v27, v233, v6
    v_dot2c_f32_bf16 v28, v234, v82
    v_dot2c_f32_bf16 v29, v234, v6
    v_dot2c_f32_bf16 v30, v235, v82
    v_dot2c_f32_bf16 v31, v235, v6
    v_lshlrev_b32 v6, 16, v83
    s_waitcnt vmcnt(0)
    v_dot2c_f32_bf16 v24, v236, v83
    v_dot2c_f32_bf16 v25, v236, v6
    v_dot2c_f32_bf16 v26, v237, v83
    v_dot2c_f32_bf16 v27, v237, v6
    v_dot2c_f32_bf16 v28, v238, v83
    v_dot2c_f32_bf16 v29, v238, v6
    v_dot2c_f32_bf16 v30, v239, v83
    v_dot2c_f32_bf16 v31, v239, v6
    s_mov_b32 s80, 131072
L_fchk:
    v_cmp_le_f32 vcc, 0, v42
    s_cbranch_vccnz L_fok
    s_sleep 4
    ds_read_b32 v42, v4 offset:2688
    s_waitcnt lgkmcnt(0)
    s_sub_u32 s80, s80, 1
    s_cmp_lg_u32 s80, 0
    s_cbranch_scc1 L_fchk
L_fok:
    v_permlane32_swap_b32 v24, v28
    v_permlane32_swap_b32 v25, v29
    v_permlane32_swap_b32 v26, v30
    v_permlane32_swap_b32 v27, v31
    v_pk_add_f32 v[24:25], v[24:25], v[28:29]
    v_pk_add_f32 v[26:27], v[26:27], v[30:31]
    v_pk_mul_f32 v[24:25], v[24:25], v[42:43] op_sel_hi:[1,0]
    v_pk_mul_f32 v[26:27], v[26:27], v[42:43] op_sel_hi:[1,0]
    ds_write_b128 v5, v[24:27] offset:3072
    s_waitcnt lgkmcnt(0)
    s_barrier
    s_endpgm
L_helper:
    s_load_dword s78, s[28:29], 0
    s_mov_b32 s48, s28
    s_mov_b32 s49, s29
    s_mov_b32 s50, 67108864
    s_mov_b32 s51, 0x20000
    s_sub_u32 s76, s52, 4
    s_cmp_lg_u32 s76, 0
    s_cbranch_scc1 L_h_notq
    s_mov_b32 s44, s4
    s_mov_b32 s45, s5
    s_mov_b32 s46, 896
    s_mov_b32 s47, 0x20000
    v_lshlrev_b32 v4, 1, v1
    buffer_load_ushort v44, v4, s[44:47], 0 offen offset:0 nt
    buffer_load_ushort v45, v4, s[44:47], 0 offen offset:128 nt
    buffer_load_ushort v46, v4, s[44:47], 0 offen offset:256 nt
    buffer_load_ushort v47, v4, s[44:47], 0 offen offset:384 nt
    buffer_load_ushort v48, v4, s[44:47], 0 offen offset:512 nt
    buffer_load_ushort v49, v4, s[44:47], 0 offen offset:640 nt
    buffer_load_ushort v50, v4, s[44:47], 0 offen offset:768 nt
    s_lshl_b32 s54, s30, 9
    s_lshl_b32 s79, s31, 5
    s_add_u32 s54, s54, s79
    s_add_u32 s40, s10, s54
    s_addc_u32 s41, s11, 0
    s_sub_u32 s42, 3670016, s54
    s_mov_b32 s43, 0x20000
    v_lshrrev_b32 v5, 2, v1
    v_lshlrev_b32 v2, 13, v5
    v_and_b32 v6, 3, v1
    v_lshl_add_u32 v2, v6, 3, v2
    s_mov_b32 s54, 0
    buffer_load_dwordx2 v[112:113], v2, s[40:43], s54 offen nt
    s_mov_b32 s54, 131072
    buffer_load_dwordx2 v[114:115], v2, s[40:43], s54 offen nt
    s_mov_b32 s54, 262144
    buffer_load_dwordx2 v[116:117], v2, s[40:43], s54 offen nt
    s_mov_b32 s54, 393216
    buffer_load_dwordx2 v[118:119], v2, s[40:43], s54 offen nt
    s_mov_b32 s54, 524288
    buffer_load_dwordx2 v[120:121], v2, s[40:43], s54 offen nt
    s_mov_b32 s54, 655360
    buffer_load_dwordx2 v[122:123], v2, s[40:43], s54 offen nt
    s_mov_b32 s54, 786432
    buffer_load_dwordx2 v[124:125], v2, s[40:43], s54 offen nt
    s_mov_b32 s54, 917504
    buffer_load_dwordx2 v[126:127], v2, s[40:43], s54 offen nt
    s_mov_b32 s54, 1048576
    buffer_load_dwordx2 v[128:129], v2, s[40:43], s54 offen nt
    s_mov_b32 s54, 1179648
    buffer_load_dwordx2 v[130:131], v2, s[40:43], s54 offen nt
    s_mov_b32 s54, 1310720
    buffer_load_dwordx2 v[132:133], v2, s[40:43], s54 offen nt
    s_mov_b32 s54, 1441792
    buffer_load_dwordx2 v[134:135], v2, s[40:43], s54 offen nt
    s_mov_b32 s54, 1572864
    buffer_load_dwordx2 v[136:137], v2, s[40:43], s54 offen nt
    s_mov_b32 s54, 1703936
    buffer_load_dwordx2 v[138:139], v2, s[40:43], s54 offen nt
    s_mov_b32 s54, 1835008
    buffer_load_dwordx2 v[140:141], v2, s[40:43], s54 offen nt
    s_mov_b32 s54, 1966080
    buffer_load_dwordx2 v[142:143], v2, s[40:43], s54 offen nt
    s_mov_b32 s54, 2097152
    buffer_load_dwordx2 v[144:145], v2, s[40:43], s54 offen nt
    s_mov_b32 s54, 2228224
    buffer_load_dwordx2 v[146:147], v2, s[40:43], s54 offen nt
    s_mov_b32 s54, 2359296
    buffer_load_dwordx2 v[148:149], v2, s[40:43], s54 offen nt
    s_mov_b32 s54, 2490368
    buffer_load_dwordx2 v[150:151], v2, s[40:43], s54 offen nt
    s_mov_b32 s54, 2621440
    buffer_load_dwordx2 v[152:153], v2, s[40:43], s54 offen nt
    s_mov_b32 s54, 2752512
    buffer_load_dwordx2 v[154:155], v2, s[40:43], s54 offen nt
    s_mov_b32 s54, 2883584
    buffer_load_dwordx2 v[156:157], v2, s[40:43], s54 offen nt
    s_mov_b32 s54, 3014656
    buffer_load_dwordx2 v[158:159], v2, s[40:43], s54 offen nt
    s_mov_b32 s54, 3145728
    buffer_load_dwordx2 v[160:161], v2, s[40:43], s54 offen nt
    s_mov_b32 s54, 3276800
    buffer_load_dwordx2 v[162:163], v2, s[40:43], s54 offen nt
    s_mov_b32 s54, 3407872
    buffer_load_dwordx2 v[164:165], v2, s[40:43], s54 offen nt
    s_mov_b32 s54, 3538944
    buffer_load_dwordx2 v[166:167], v2, s[40:43], s54 offen nt
    s_waitcnt vmcnt(28)
    v_lshlrev_b32 v44, 16, v44
    v_lshlrev_b32 v45, 16, v45
    v_lshlrev_b32 v46, 16, v46
    v_lshlrev_b32 v47, 16, v47
    v_lshlrev_b32 v48, 16, v48
    v_lshlrev_b32 v49, 16, v49
    v_lshlrev_b32 v50, 16, v50
    v_readfirstlane_b32 s94, v44
    s_nop 1
    v_subrev_f32 v24, s94, v44
    v_subrev_f32 v25, s94, v45
    v_subrev_f32 v26, s94, v46
    v_subrev_f32 v27, s94, v47
    v_subrev_f32 v28, s94, v48
    v_subrev_f32 v29, s94, v49
    v_subrev_f32 v30, s94, v50
    v_add_f32 v40, v24, v25
    v_mul_f32 v41, v24, v24
    v_fmac_f32 v41, v25, v25
    v_add_f32 v40, v40, v26
    v_fmac_f32 v41, v26, v26
    v_add_f32 v40, v40, v27
    v_fmac_f32 v41, v27, v27
    v_add_f32 v40, v40, v28
    v_fmac_f32 v41, v28, v28
    v_add_f32 v40, v40, v29
    v_fmac_f32 v41, v29, v29
    v_add_f32 v40, v40, v30
    v_fmac_f32 v41, v30, v30
    s_nop 0
    v_add_f32_dpp v40, v40, v40 row_ror:8 row_mask:0xf bank_mask:0xf
    v_add_f32_dpp v41, v41, v41 row_ror:8 row_mask:0xf bank_mask:0xf
    s_nop 0
    v_add_f32_dpp v40, v40, v40 row_ror:4 row_mask:0xf bank_mask:0xf
    v_add_f32_dpp v41, v41, v41 row_ror:4 row_mask:0xf bank_mask:0xf
    s_nop 0
    v_add_f32_dpp v40, v40, v40 row_ror:2 row_mask:0xf bank_mask:0xf
    v_add_f32_dpp v41, v41, v41 row_ror:2 row_mask:0xf bank_mask:0xf
    s_nop 0
    v_add_f32_dpp v40, v40, v40 row_ror:1 row_mask:0xf bank_mask:0xf
    v_add_f32_dpp v41, v41, v41 row_ror:1 row_mask:0xf bank_mask:0xf
    v_mov_b32 v6, v40
    v_mov_b32 v7, v41
    s_nop 0
    v_permlane16_swap_b32 v40, v6
    v_permlane16_swap_b32 v41, v7
    v_add_f32 v40, v40, v6
    v_add_f32 v41, v41, v7
    v_mov_b32 v6, v40
    v_mov_b32 v7, v41
    s_nop 0
    v_permlane32_swap_b32 v40, v6
    v_permlane32_swap_b32 v41, v7
    v_add_f32 v40, v40, v6
    v_add_f32 v41, v41, v7
    v_mul_f32 v40, 0.002232142857142857, v40
    v_mul_f32 v41, 0.002232142857142857, v41
    v_fma_f32 v41, -v40, v40, v41
    v_add_f32 v40, s94, v40
    v_cvt_pk_bf16_f32 v41, v41, v41
    v_lshlrev_b32 v41, 16, v41
    v_add_f32 v41, 1e-05, v41
    v_cvt_pk_bf16_f32 v41, v41, v41
    v_lshlrev_b32 v41, 16, v41
    v_sqrt_f32 v41, v41
    v_cvt_pk_bf16_f32 v40, v40, v40
    v_cvt_pk_bf16_f32 v41, v41, v41
    v_lshlrev_b32 v40, 16, v40
    v_lshlrev_b32 v41, 16, v41
    v_rcp_f32 v42, v41
    v_and_b32 v4, 15, v1
    v_mul_u32_u24 v4, 112, v4
    v_lshrrev_b32 v7, 4, v1
    v_lshl_add_u32 v4, v7, 2, v4
    v_sub_f32 v44, v44, v40
    v_sub_f32 v45, v45, v40
    v_sub_f32 v46, v46, v40
    v_sub_f32 v47, v47, v40
    v_sub_f32 v48, v48, v40
    v_sub_f32 v49, v49, v40
    v_sub_f32 v50, v50, v40
    v_cvt_pk_bf16_f32 v44, v44, v44
    v_lshlrev_b32 v44, 16, v44
    v_cvt_pk_bf16_f32 v45, v45, v45
    v_lshlrev_b32 v45, 16, v45
    v_cvt_pk_bf16_f32 v46, v46, v46
    v_lshlrev_b32 v46, 16, v46
    v_cvt_pk_bf16_f32 v47, v47, v47
    v_lshlrev_b32 v47, 16, v47
    v_cvt_pk_bf16_f32 v48, v48, v48
    v_lshlrev_b32 v48, 16, v48
    v_cvt_pk_bf16_f32 v49, v49, v49
    v_lshlrev_b32 v49, 16, v49
    v_cvt_pk_bf16_f32 v50, v50, v50
    v_lshlrev_b32 v50, 16, v50
    v_mul_f32 v44, v44, v42
    v_mul_f32 v45, v45, v42
    v_mul_f32 v46, v46, v42
    v_mul_f32 v47, v47, v42
    v_mul_f32 v48, v48, v42
    v_mul_f32 v49, v49, v42
    v_mul_f32 v50, v50, v42
    v_cvt_pk_bf16_f32 v44, v44, 0
    ds_write_b32 v4, v44 offset:0
    v_cvt_pk_bf16_f32 v45, v45, 0
    ds_write_b32 v4, v45 offset:16
    v_cvt_pk_bf16_f32 v46, v46, 0
    ds_write_b32 v4, v46 offset:32
    v_cvt_pk_bf16_f32 v47, v47, 0
    ds_write_b32 v4, v47 offset:48
    v_cvt_pk_bf16_f32 v48, v48, 0
    ds_write_b32 v4, v48 offset:64
    v_cvt_pk_bf16_f32 v49, v49, 0
    ds_write_b32 v4, v49 offset:80
    v_cvt_pk_bf16_f32 v50, v50, 0
    ds_write_b32 v4, v50 offset:96
    v_mul_u32_u24 v4, 112, v5
    s_waitcnt lgkmcnt(0)
    ds_read_b128 v[52:55], v4 offset:0
    ds_read_b128 v[56:59], v4 offset:16
    ds_read_b128 v[60:63], v4 offset:32
    ds_read_b128 v[64:67], v4 offset:48
    ds_read_b128 v[68:71], v4 offset:64
    ds_read_b128 v[72:75], v4 offset:80
    ds_read_b128 v[76:79], v4 offset:96
    v_mov_b32 v24, 0
    v_mov_b32 v25, 0
    v_mov_b32 v26, 0
    v_mov_b32 v27, 0
    s_mul_i32 s77, s78, 0x9e3779b1
    s_add_u32 s77, s77, 0x7f4a7c15
    s_waitcnt lgkmcnt(0)
    v_lshlrev_b32 v6, 16, v52
    s_waitcnt vmcnt(27)
    v_dot2c_f32_bf16 v24, v112, v52
    v_dot2c_f32_bf16 v25, v112, v6
    v_dot2c_f32_bf16 v26, v113, v52
    v_dot2c_f32_bf16 v27, v113, v6
    v_lshlrev_b32 v6, 16, v53
    s_waitcnt vmcnt(26)
    v_dot2c_f32_bf16 v24, v114, v53
    v_dot2c_f32_bf16 v25, v114, v6
    v_dot2c_f32_bf16 v26, v115, v53
    v_dot2c_f32_bf16 v27, v115, v6
    v_lshlrev_b32 v6, 16, v54
    s_waitcnt vmcnt(25)
    v_dot2c_f32_bf16 v24, v116, v54
    v_dot2c_f32_bf16 v25, v116, v6
    v_dot2c_f32_bf16 v26, v117, v54
    v_dot2c_f32_bf16 v27, v117, v6
    v_lshlrev_b32 v6, 16, v55
    s_waitcnt vmcnt(24)
    v_dot2c_f32_bf16 v24, v118, v55
    v_dot2c_f32_bf16 v25, v118, v6
    v_dot2c_f32_bf16 v26, v119, v55
    v_dot2c_f32_bf16 v27, v119, v6
    v_lshlrev_b32 v6, 16, v56
    s_waitcnt vmcnt(23)
    v_dot2c_f32_bf16 v24, v120, v56
    v_dot2c_f32_bf16 v25, v120, v6
    v_dot2c_f32_bf16 v26, v121, v56
    v_dot2c_f32_bf16 v27, v121, v6
    v_lshlrev_b32 v6, 16, v57
    s_waitcnt vmcnt(22)
    v_dot2c_f32_bf16 v24, v122, v57
    v_dot2c_f32_bf16 v25, v122, v6
    v_dot2c_f32_bf16 v26, v123, v57
    v_dot2c_f32_bf16 v27, v123, v6
    v_lshlrev_b32 v6, 16, v58
    s_waitcnt vmcnt(21)
    v_dot2c_f32_bf16 v24, v124, v58
    v_dot2c_f32_bf16 v25, v124, v6
    v_dot2c_f32_bf16 v26, v125, v58
    v_dot2c_f32_bf16 v27, v125, v6
    v_lshlrev_b32 v6, 16, v59
    s_waitcnt vmcnt(20)
    v_dot2c_f32_bf16 v24, v126, v59
    v_dot2c_f32_bf16 v25, v126, v6
    v_dot2c_f32_bf16 v26, v127, v59
    v_dot2c_f32_bf16 v27, v127, v6
    v_lshlrev_b32 v6, 16, v60
    s_waitcnt vmcnt(19)
    v_dot2c_f32_bf16 v24, v128, v60
    v_dot2c_f32_bf16 v25, v128, v6
    v_dot2c_f32_bf16 v26, v129, v60
    v_dot2c_f32_bf16 v27, v129, v6
    v_lshlrev_b32 v6, 16, v61
    s_waitcnt vmcnt(18)
    v_dot2c_f32_bf16 v24, v130, v61
    v_dot2c_f32_bf16 v25, v130, v6
    v_dot2c_f32_bf16 v26, v131, v61
    v_dot2c_f32_bf16 v27, v131, v6
    v_lshlrev_b32 v6, 16, v62
    s_waitcnt vmcnt(17)
    v_dot2c_f32_bf16 v24, v132, v62
    v_dot2c_f32_bf16 v25, v132, v6
    v_dot2c_f32_bf16 v26, v133, v62
    v_dot2c_f32_bf16 v27, v133, v6
    v_lshlrev_b32 v6, 16, v63
    s_waitcnt vmcnt(16)
    v_dot2c_f32_bf16 v24, v134, v63
    v_dot2c_f32_bf16 v25, v134, v6
    v_dot2c_f32_bf16 v26, v135, v63
    v_dot2c_f32_bf16 v27, v135, v6
    v_lshlrev_b32 v6, 16, v64
    s_waitcnt vmcnt(15)
    v_dot2c_f32_bf16 v24, v136, v64
    v_dot2c_f32_bf16 v25, v136, v6
    v_dot2c_f32_bf16 v26, v137, v64
    v_dot2c_f32_bf16 v27, v137, v6
    v_lshlrev_b32 v6, 16, v65
    s_waitcnt vmcnt(14)
    v_dot2c_f32_bf16 v24, v138, v65
    v_dot2c_f32_bf16 v25, v138, v6
    v_dot2c_f32_bf16 v26, v139, v65
    v_dot2c_f32_bf16 v27, v139, v6
    v_lshlrev_b32 v6, 16, v66
    s_waitcnt vmcnt(13)
    v_dot2c_f32_bf16 v24, v140, v66
    v_dot2c_f32_bf16 v25, v140, v6
    v_dot2c_f32_bf16 v26, v141, v66
    v_dot2c_f32_bf16 v27, v141, v6
    v_lshlrev_b32 v6, 16, v67
    s_waitcnt vmcnt(12)
    v_dot2c_f32_bf16 v24, v142, v67
    v_dot2c_f32_bf16 v25, v142, v6
    v_dot2c_f32_bf16 v26, v143, v67
    v_dot2c_f32_bf16 v27, v143, v6
    v_lshlrev_b32 v6, 16, v68
    s_waitcnt vmcnt(11)
    v_dot2c_f32_bf16 v24, v144, v68
    v_dot2c_f32_bf16 v25, v144, v6
    v_dot2c_f32_bf16 v26, v145, v68
    v_dot2c_f32_bf16 v27, v145, v6
    v_lshlrev_b32 v6, 16, v69
    s_waitcnt vmcnt(10)
    v_dot2c_f32_bf16 v24, v146, v69
    v_dot2c_f32_bf16 v25, v146, v6
    v_dot2c_f32_bf16 v26, v147, v69
    v_dot2c_f32_bf16 v27, v147, v6
    v_lshlrev_b32 v6, 16, v70
    s_waitcnt vmcnt(9)
    v_dot2c_f32_bf16 v24, v148, v70
    v_dot2c_f32_bf16 v25, v148, v6
    v_dot2c_f32_bf16 v26, v149, v70
    v_dot2c_f32_bf16 v27, v149, v6
    v_lshlrev_b32 v6, 16, v71
    s_waitcnt vmcnt(8)
    v_dot2c_f32_bf16 v24, v150, v71
    v_dot2c_f32_bf16 v25, v150, v6
    v_dot2c_f32_bf16 v26, v151, v71
    v_dot2c_f32_bf16 v27, v151, v6
    v_lshlrev_b32 v6, 16, v72
    s_waitcnt vmcnt(7)
    v_dot2c_f32_bf16 v24, v152, v72
    v_dot2c_f32_bf16 v25, v152, v6
    v_dot2c_f32_bf16 v26, v153, v72
    v_dot2c_f32_bf16 v27, v153, v6
    v_lshlrev_b32 v6, 16, v73
    s_waitcnt vmcnt(6)
    v_dot2c_f32_bf16 v24, v154, v73
    v_dot2c_f32_bf16 v25, v154, v6
    v_dot2c_f32_bf16 v26, v155, v73
    v_dot2c_f32_bf16 v27, v155, v6
    v_lshlrev_b32 v6, 16, v74
    s_waitcnt vmcnt(5)
    v_dot2c_f32_bf16 v24, v156, v74
    v_dot2c_f32_bf16 v25, v156, v6
    v_dot2c_f32_bf16 v26, v157, v74
    v_dot2c_f32_bf16 v27, v157, v6
    v_lshlrev_b32 v6, 16, v75
    s_waitcnt vmcnt(4)
    v_dot2c_f32_bf16 v24, v158, v75
    v_dot2c_f32_bf16 v25, v158, v6
    v_dot2c_f32_bf16 v26, v159, v75
    v_dot2c_f32_bf16 v27, v159, v6
    v_lshlrev_b32 v6, 16, v76
    s_waitcnt vmcnt(3)
    v_dot2c_f32_bf16 v24, v160, v76
    v_dot2c_f32_bf16 v25, v160, v6
    v_dot2c_f32_bf16 v26, v161, v76
    v_dot2c_f32_bf16 v27, v161, v6
    v_lshlrev_b32 v6, 16, v77
    s_waitcnt vmcnt(2)
    v_dot2c_f32_bf16 v24, v162, v77
    v_dot2c_f32_bf16 v25, v162, v6
    v_dot2c_f32_bf16 v26, v163, v77
    v_dot2c_f32_bf16 v27, v163, v6
    v_lshlrev_b32 v6, 16, v78
    s_waitcnt vmcnt(1)
    v_dot2c_f32_bf16 v24, v164, v78
    v_dot2c_f32_bf16 v25, v164, v6
    v_dot2c_f32_bf16 v26, v165, v78
    v_dot2c_f32_bf16 v27, v165, v6
    v_lshlrev_b32 v6, 16, v79
    s_waitcnt vmcnt(0)
    v_dot2c_f32_bf16 v24, v166, v79
    v_dot2c_f32_bf16 v25, v166, v6
    v_dot2c_f32_bf16 v26, v167, v79
    v_dot2c_f32_bf16 v27, v167, v6
    s_nop 2
    v_permlane32_swap_b32 v24, v26
    v_permlane32_swap_b32 v25, v27
    v_add_f32 v24, v24, v26
    v_add_f32 v25, v25, v27
    s_nop 1
    v_permlane16_swap_b32 v24, v25
    v_add_f32 v24, v24, v25
    s_nop 1
    v_add_f32_dpp v24, v24, v24 row_ror:8 row_mask:0xf bank_mask:0xf
    s_nop 1
    v_add_f32_dpp v24, v24, v24 row_ror:4 row_mask:0xf bank_mask:0xf
    v_mov_b32 v25, v24
    v_and_b32 v4, 3, v1
    v_lshl_add_u32 v4, v4, 1, v11
    v_permlane16_swap_b32 v24, v25
    v_lshlrev_b32 v4, 3, v4
    v_cvt_pk_bf16_f32 v26, v24, v25
    v_mov_b32 v27, s77
    s_lshl_b32 s54, s30, 10
    s_lshl_b32 s79, s31, 6
    s_add_u32 s79, s79, s54
    s_add_u32 s79, s79, 4096
    s_mov_b32 exec_lo, 0xf
    s_mov_b32 exec_hi, 0xf
    buffer_store_dwordx2 v[26:27], v4, s[48:51], s79 offen
    s_add_u32 s79, s79, 16384
    buffer_store_dwordx2 v[26:27], v4, s[48:51], s79 offen sc1
    s_mov_b64 exec, -1
    v_lshlrev_b32 v4, 4, v1
    s_add_u32 s54, s54, 4096
    s_mov_b32 s79, s54
    s_mov_b32 s80, 131072
L_poll_q_1:
    buffer_load_dwordx4 v[24:27], v4, s[48:51], s79 offen sc1
    s_waitcnt vmcnt(0)
    v_cmp_eq_u32 vcc, s77, v25
    v_cmp_eq_u32 s[82:83], s77, v27
    s_and_b64 vcc, vcc, s[82:83]
    s_andn2_b64 exec, exec, vcc
    s_cbranch_scc0 L_poll_q_1_ok
    s_sub_u32 s80, s80, 1
    s_and_b32 s79, s80, 63
    s_cmp_eq_u32 s79, 0
    s_cselect_b32 s79, 16384, 0
    s_add_u32 s79, s79, s54
    s_cmp_lg_u32 s80, 0
    s_cbranch_scc1 L_poll_q_1
L_poll_q_1_ok:
    s_mov_b64 exec, -1
    v_mov_b32 v25, v26
    v_lshlrev_b32 v4, 3, v1
    ds_write_b64 v4, v[24:25] offset:2048
    s_waitcnt lgkmcnt(0)
    s_branch L_h_barA
L_h_notq:
    s_cmp_eq_u32 s76, 1
    s_cbranch_scc0 L_h_noth1
    v_mov_b32 v5, -1.0
    v_lshlrev_b32 v4, 2, v1
    s_mov_b64 exec, 0xffffff
    ds_write_b32 v4, v5 offset:2624
    s_mov_b64 exec, -1
L_h_noth1:
    s_waitcnt lgkmcnt(0)
    s_mul_i32 s77, s78, 0x9e3779b1
    s_add_u32 s77, s77, 0x7f4a7c15
    s_cmp_lt_u32 s2, 80
    s_cbranch_scc0 L_h_barA
    s_cmp_eq_u32 s76, 2
    s_cbranch_scc0 L_h_barA
    v_mov_b32 v24, 0
    v_mov_b32 v25, 0
    v_mov_b32 v26, 0
    v_mov_b32 v27, 0
    v_lshlrev_b32 v4, 4, v1
    s_lshl_b32 s54, s2, 10
    s_add_u32 s79, s54, 180224
    s_add_u32 s54, s54, 65536
    s_cmp_lt_u32 s2, 16
    s_cselect_b32 s54, s54, s79
    buffer_store_dwordx4 v[24:27], v4, s[48:51], s54 offen sc1
    s_waitcnt vmcnt(0)
    v_mov_b32 v24, 1
    v_mov_b32 v25, s77
    v_mov_b32 v4, 0
    s_lshl_b32 s54, s2, 3
    s_add_u32 s54, s54, 1024
    s_mov_b64 exec, 1
    buffer_store_dwordx2 v[24:25], v4, s[48:51], s54 offen sc1
    s_mov_b64 exec, -1
L_h_barA:
    s_waitcnt vmcnt(0)
    s_barrier
    v_mov_b32 v76, 0
    v_mov_b32 v77, 0
    v_mov_b32 v78, 0
    v_mov_b32 v79, 0
    s_lshl_b32 s54, s76, 6
    v_add_u32 v3, s54, v1
    s_movk_i32 s79, 224
    v_cmp_gt_u32 s[86:87], s79, v3
    v_cmp_gt_u32 s[88:89], 56, v1
    v_cmp_gt_u32 s[92:93], 55, v1
    v_and_b32 v4, 3, v1
    v_cmp_ne_u32 s[90:91], 3, v4
    s_and_b64 s[94:95], s[90:91], s[88:89]
    s_and_b32 s53, s2, 7
    s_mul_i32 s53, s53, 28
    s_lshr_b32 s54, s2, 3
    s_add_u32 s53, s53, s54
    s_mul_i32 s55, s76, 10240
    s_add_u32 s55, s55, 30720
    s_mul_i32 s54, s76, 120
    s_and_b32 s54, s54, 0xfffffff0
    v_lshrrev_b32 v4, 3, v1
    v_mul_u32_u24 v4, 896, v4
    v_and_b32 v5, 7, v1
    v_lshl_add_u32 v4, v5, 4, v4
    v_add_u32 v2, s54, v4
    s_lshl_b32 s54, s30, 8
    s_lshl_b32 s79, s31, 4
    s_add_u32 s54, s54, s79
    s_mul_i32 s54, s54, 896
    s_add_u32 s40, s12, s54
    s_addc_u32 s41, s13, 0
    s_sub_u32 s42, 3670016, s54
    s_mov_b32 s43, 0x20000
    s_add_u32 m0, s55, 0
    s_mov_b32 s79, 0
    buffer_load_dwordx4 v2, s[40:43], s79 offen nt lds
    s_waitcnt vmcnt(0)
    s_add_u32 m0, s55, 1024
    s_mov_b32 s79, 7168
    buffer_load_dwordx4 v2, s[40:43], s79 offen nt lds
    s_waitcnt vmcnt(0)
    s_add_u32 m0, s55, 2048
    s_mov_b32 s79, 480
    buffer_load_dwordx4 v2, s[40:43], s79 offen nt lds
    s_waitcnt vmcnt(0)
    s_add_u32 m0, s55, 3072
    s_mov_b32 s79, 7648
    buffer_load_dwordx4 v2, s[40:43], s79 offen nt lds
    s_waitcnt vmcnt(0)
    s_cmp_ge_u32 s2, 8
    s_cselect_b32 s58, 1, 0
    s_cmp_eq_u32 s76, 0
    s_cselect_b32 s58, 0, s58
    s_cmp_lt_u32 s2, 224
    s_cbranch_scc0 L_t_nomlp1
    s_cmp_eq_u32 s58, 1
    s_cbranch_scc1 L_t_nomlp1
    s_mul_i32 s54, s53, 7168
    s_add_u32 s40, s20, s54
    s_addc_u32 s41, s21, 0
    s_sub_u32 s42, 1605632, s54
    s_mov_b32 s43, 0x20000
    s_add_u32 m0, s55, 4096
    s_mov_b32 s79, 0
    buffer_load_dwordx4 v2, s[40:43], s79 offen nt lds
    s_waitcnt vmcnt(0)
    s_add_u32 m0, s55, 5120
    s_mov_b32 s79, 480
    buffer_load_dwordx4 v2, s[40:43], s79 offen nt lds
    s_waitcnt vmcnt(0)
    s_lshl_b32 s54, s53, 4
    s_add_u32 s44, s16, s54
    s_addc_u32 s45, s17, 0
    s_sub_u32 s46, 1605632, s54
    s_mov_b32 s47, 0x20000
    s_mul_i32 s79, s76, 120
    v_add_u32 v4, s79, v1
    s_movk_i32 s79, 3584
    v_mul_lo_u32 v6, v4, s79
    s_add_u32 m0, s55, 6144
    s_mov_b32 s79, 0
    buffer_load_dwordx4 v6, s[44:47], s79 offen nt lds
    s_waitcnt vmcnt(0)
    v_add_u32 v7, 229376, v6
    s_add_u32 m0, s55, 7168
    s_mov_b32 s79, 0
    buffer_load_dwordx4 v7, s[44:47], s79 offen nt lds
    s_waitcnt vmcnt(0)
    s_add_u32 s40, s18, s54
    s_addc_u32 s41, s19, 0
    s_sub_u32 s42, 3584, s54
    s_mov_b32 s43, 0x20000
    v_and_b32 v4, 7, v1
    v_lshlrev_b32 v4, 1, v4
    buffer_load_ushort v66, v4, s[40:43], 0 offen nt
    s_waitcnt vmcnt(0)
    v_lshlrev_b32 v66, 16, v66
    s_cmp_lt_u32 s2, 8
    s_cbranch_scc0 L_t_nomlp1
    v_lshlrev_b32 v6, 4, v1
    s_mov_b32 s44, s4
    s_mov_b32 s45, s5
    s_mov_b32 s46, 896
    s_mov_b32 s47, 0x20000
    s_add_u32 m0, s55, 8192
    s_mov_b32 s79, 0
    buffer_load_dwordx4 v6, s[44:47], s79 offen nt lds
    s_waitcnt vmcnt(0)
    s_mov_b32 s44, s22
    s_mov_b32 s45, s23
    s_mov_b32 s46, 896
    s_mov_b32 s47, 0x20000
    s_add_u32 m0, s55, 9216
    s_mov_b32 s79, 0
    buffer_load_dwordx4 v6, s[44:47], s79 offen nt lds
    s_waitcnt vmcnt(0)
L_t_nomlp1:
    v_and_b32 v5, 15, v1
    v_lshrrev_b32 v6, 4, v1
    v_mul_u32_u24 v6, 15, v6
    v_add_u32 v6, v6, v5
    s_and_b32 s54, s76, 1
    s_lshl_b32 s54, s54, 3
    s_add_u32 s54, s54, s55
    v_lshl_add_u32 v4, v6, 1, s54
    v_cmp_gt_u32 s[82:83], 15, v5
    s_mul_i32 s54, s76, 60
    v_add_u32 v7, s54, v6
    s_movk_i32 s79, 208
    v_cmp_gt_u32 s[84:85], s79, v7
    s_and_b64 s[84:85], s[84:85], s[82:83]
    v_mov_b32 v7, 1.0
    v_cndmask_b32 v64, v7, 0, s[82:83]
    v_mov_b32 v65, v64
    ds_read_u16 v112, v4 offset:0
    ds_read_u16 v113, v4 offset:128
    ds_read_u16 v114, v4 offset:256
    ds_read_u16 v115, v4 offset:384
    ds_read_u16 v116, v4 offset:512
    ds_read_u16 v117, v4 offset:640
    ds_read_u16 v118, v4 offset:768
    ds_read_u16 v119, v4 offset:896
    ds_read_u16 v120, v4 offset:1024
    ds_read_u16 v121, v4 offset:1152
    ds_read_u16 v122, v4 offset:1280
    ds_read_u16 v123, v4 offset:1408
    ds_read_u16 v124, v4 offset:1536
    ds_read_u16 v125, v4 offset:1664
    s_waitcnt lgkmcnt(0)
    v_lshl_or_b32 v16, v113, 16, v112
    v_lshl_or_b32 v17, v115, 16, v114
    v_lshl_or_b32 v18, v117, 16, v116
    v_lshl_or_b32 v19, v119, 16, v118
    v_lshl_or_b32 v20, v121, 16, v120
    v_lshl_or_b32 v21, v123, 16, v122
    v_lshl_or_b32 v22, v125, 16, v124
    ds_read_u16 v112, v4 offset:1792
    ds_read_u16 v113, v4 offset:1920
    ds_read_u16 v114, v4 offset:2048
    ds_read_u16 v115, v4 offset:2176
    ds_read_u16 v116, v4 offset:2304
    ds_read_u16 v117, v4 offset:2432
    ds_read_u16 v118, v4 offset:2560
    ds_read_u16 v119, v4 offset:2688
    ds_read_u16 v120, v4 offset:2816
    ds_read_u16 v121, v4 offset:2944
    ds_read_u16 v122, v4 offset:3072
    ds_read_u16 v123, v4 offset:3200
    ds_read_u16 v124, v4 offset:3328
    ds_read_u16 v125, v4 offset:3456
    s_waitcnt lgkmcnt(0)
    v_lshl_or_b32 v23, v113, 16, v112
    v_lshl_or_b32 v24, v115, 16, v114
    v_lshl_or_b32 v25, v117, 16, v116
    v_lshl_or_b32 v26, v119, 16, v118
    v_lshl_or_b32 v27, v121, 16, v120
    v_lshl_or_b32 v28, v123, 16, v122
    v_lshl_or_b32 v29, v125, 16, v124
    ds_read_u16 v112, v4 offset:3584
    ds_read_u16 v113, v4 offset:3712
    ds_read_u16 v114, v4 offset:3840
    ds_read_u16 v115, v4 offset:3968
    s_waitcnt lgkmcnt(0)
    v_lshl_or_b32 v30, v113, 16, v112
    v_lshl_or_b32 v31, v115, 16, v114
    v_cndmask_b32 v16, 0, v16, s[82:83]
    v_cndmask_b32 v24, 0, v24, s[84:85]
    v_cndmask_b32 v17, 0, v17, s[82:83]
    v_cndmask_b32 v25, 0, v25, s[84:85]
    v_cndmask_b32 v18, 0, v18, s[82:83]
    v_cndmask_b32 v26, 0, v26, s[84:85]
    v_cndmask_b32 v19, 0, v19, s[82:83]
    v_cndmask_b32 v27, 0, v27, s[84:85]
    v_cndmask_b32 v20, 0, v20, s[82:83]
    v_cndmask_b32 v28, 0, v28, s[84:85]
    v_cndmask_b32 v21, 0, v21, s[82:83]
    v_cndmask_b32 v29, 0, v29, s[84:85]
    v_cndmask_b32 v22, 0, v22, s[82:83]
    v_cndmask_b32 v30, 0, v30, s[84:85]
    v_cndmask_b32 v23, 0, v23, s[82:83]
    v_cndmask_b32 v31, 0, v31, s[84:85]
    s_cmp_lt_u32 s2, 224
    s_cbranch_scc0 L_t_skippre
    s_cmp_eq_u32 s58, 1
    s_cbranch_scc1 L_t_skippre
    ds_read_u16 v112, v4 offset:4096
    ds_read_u16 v113, v4 offset:4224
    ds_read_u16 v114, v4 offset:4352
    ds_read_u16 v115, v4 offset:4480
    ds_read_u16 v116, v4 offset:4608
    ds_read_u16 v117, v4 offset:4736
    ds_read_u16 v118, v4 offset:4864
    ds_read_u16 v119, v4 offset:4992
    s_waitcnt lgkmcnt(0)
    v_lshl_or_b32 v56, v113, 16, v112
    v_lshl_or_b32 v57, v115, 16, v114
    v_lshl_or_b32 v58, v117, 16, v116
    v_lshl_or_b32 v59, v119, 16, v118
    ds_read_u16 v112, v4 offset:5120
    ds_read_u16 v113, v4 offset:5248
    ds_read_u16 v114, v4 offset:5376
    ds_read_u16 v115, v4 offset:5504
    ds_read_u16 v116, v4 offset:5632
    ds_read_u16 v117, v4 offset:5760
    ds_read_u16 v118, v4 offset:5888
    ds_read_u16 v119, v4 offset:6016
    s_waitcnt lgkmcnt(0)
    v_lshl_or_b32 v60, v113, 16, v112
    v_lshl_or_b32 v61, v115, 16, v114
    v_lshl_or_b32 v62, v117, 16, v116
    v_lshl_or_b32 v63, v119, 16, v118
    v_cndmask_b32 v56, 0, v56, s[82:83]
    v_cndmask_b32 v60, 0, v60, s[84:85]
    v_cndmask_b32 v57, 0, v57, s[82:83]
    v_cndmask_b32 v61, 0, v61, s[84:85]
    v_cndmask_b32 v58, 0, v58, s[82:83]
    v_cndmask_b32 v62, 0, v62, s[84:85]
    v_cndmask_b32 v59, 0, v59, s[82:83]
    v_cndmask_b32 v63, 0, v63, s[84:85]
    v_lshrrev_b32 v5, 3, v1
    v_mul_u32_u24 v5, 240, v5
    v_and_b32 v6, 7, v1
    v_lshl_add_u32 v5, v6, 1, v5
    v_add_u32 v5, s55, v5
    ds_read_u16 v112, v5 offset:6144
    ds_read_u16 v113, v5 offset:6160
    ds_read_u16 v114, v5 offset:6176
    ds_read_u16 v115, v5 offset:6192
    ds_read_u16 v116, v5 offset:6208
    ds_read_u16 v117, v5 offset:6224
    ds_read_u16 v118, v5 offset:6240
    ds_read_u16 v119, v5 offset:6256
    ds_read_u16 v120, v5 offset:6272
    ds_read_u16 v121, v5 offset:6288
    ds_read_u16 v122, v5 offset:6304
    ds_read_u16 v123, v5 offset:6320
    ds_read_u16 v124, v5 offset:6336
    ds_read_u16 v125, v5 offset:6352
    ds_read_u16 v126, v5 offset:6368
    v_mov_b32 v127, 0
    s_waitcnt lgkmcnt(0)
    v_lshl_or_b32 v48, v113, 16, v112
    v_lshl_or_b32 v49, v115, 16, v114
    v_lshl_or_b32 v50, v117, 16, v116
    v_lshl_or_b32 v51, v119, 16, v118
    v_lshl_or_b32 v52, v121, 16, v120
    v_lshl_or_b32 v53, v123, 16, v122
    v_lshl_or_b32 v54, v125, 16, v124
    v_lshl_or_b32 v55, v127, 16, v126
    v_lshrrev_b32 v5, 2, v1
    v_mul_u32_u24 v5, 15, v5
    v_and_b32 v6, 3, v1
    v_lshl_add_u32 v5, v6, 2, v5
    v_lshlrev_b32 v15, 1, v5
    v_add_u32 v5, s55, v15
    s_cmp_lt_u32 s2, 8
    s_cbranch_scc0 L_t_skippre
    ds_read_u16 v68, v5 offset:8192
    ds_read_u16 v69, v5 offset:8194
    ds_read_u16 v70, v5 offset:8196
    ds_read_u16 v71, v5 offset:8198
    ds_read_u16 v72, v5 offset:8672
    ds_read_u16 v73, v5 offset:8674
    ds_read_u16 v74, v5 offset:8676
    ds_read_u16 v75, v5 offset:8678
    s_waitcnt lgkmcnt(0)
    v_lshlrev_b32 v68, 16, v68
    v_lshlrev_b32 v69, 16, v69
    v_lshlrev_b32 v70, 16, v70
    v_lshlrev_b32 v71, 16, v71
    v_cndmask_b32 v71, 0, v71, s[90:91]
    v_lshlrev_b32 v72, 16, v72
    v_cndmask_b32 v72, 0, v72, s[88:89]
    v_lshlrev_b32 v73, 16, v73
    v_cndmask_b32 v73, 0, v73, s[92:93]
    v_lshlrev_b32 v74, 16, v74
    v_cndmask_b32 v74, 0, v74, s[92:93]
    v_lshlrev_b32 v75, 16, v75
    v_cndmask_b32 v75, 0, v75, s[94:95]
    s_lshl_b32 s54, s76, 3
    s_add_u32 s22, s54, s2
    v_and_b32 v4, 3, v1
    v_lshlrev_b32 v4, 2, v4
    v_lshrrev_b32 v5, 4, v1
    v_add_u32 v4, v4, v5
    s_mul_i32 s54, s22, 15
    v_add_u32 v5, s54, v4
    v_lshlrev_b32 v76, 1, v5
    v_cmp_gt_u32 s[20:21], 15, v4
    s_movk_i32 s79, 448
    v_cmp_gt_u32 s[82:83], s79, v5
    s_and_b64 s[20:21], s[20:21], s[82:83]
    s_mov_b32 s82, 0x000f000f
    s_mov_b32 s83, 0x000f000f
    s_and_b64 s[20:21], s[20:21], s[82:83]
    s_lshl_b32 s54, s22, 6
    v_lshl_add_u32 v77, v4, 2, s54
    v_add_u32 v6, s55, v76
    ds_read_u16 v78, v6 offset:9216
    v_lshrrev_b32 v79, 2, v1
    v_lshlrev_b32 v79, 11, v79
    v_and_b32 v6, 3, v1
    v_lshl_add_u32 v79, v6, 4, v79
    s_waitcnt lgkmcnt(0)
    v_lshlrev_b32 v78, 16, v78
L_t_skippre:
    s_cmp_eq_u32 s76, 1
    s_cbranch_scc0 L_t_noe1
    v_mov_b32 v4, 0
    s_mov_b32 s80, 131072
L_e1a:
    ds_read_b128 v[112:115], v4 offset:2624
    ds_read_b128 v[116:119], v4 offset:2640
    s_waitcnt lgkmcnt(0)
    v_min_f32 v5, v113, v115
    v_min3_f32 v5, v5, v117, v119
    v_cmp_le_f32 vcc, 0, v5
    s_cbranch_vccnz L_e1b
    s_sleep 32
    s_sub_u32 s80, s80, 1
    s_cmp_lg_u32 s80, 0
    s_cbranch_scc1 L_e1a
L_e1b:
    v_max_f32 v40, v112, v114
    v_max3_f32 v40, v40, v116, v118
    v_sub_f32 v120, v112, v40
    v_mul_f32 v120, 0.09016844005556021, v120
    v_exp_f32 v120, v120
    v_sub_f32 v121, v114, v40
    v_mul_f32 v121, 0.09016844005556021, v121
    v_exp_f32 v121, v121
    v_sub_f32 v122, v116, v40
    v_mul_f32 v122, 0.09016844005556021, v122
    v_exp_f32 v122, v122
    v_sub_f32 v123, v118, v40
    v_mul_f32 v123, 0.09016844005556021, v123
    v_exp_f32 v123, v123
    s_nop 0
    v_mul_f32 v41, v120, v113
    v_fmac_f32 v41, v121, v115
    v_fmac_f32 v41, v122, v117
    v_fmac_f32 v41, v123, v119
    v_mov_b32 v124, v40
    v_mov_b32 v125, s77
    v_mov_b32 v126, v41
    v_mov_b32 v127, s77
    s_lshl_b32 s54, s30, 8
    s_add_u32 s54, s54, 40960
    s_lshl_b32 s79, s31, 4
    s_add_u32 s79, s79, s54
    s_mov_b64 exec, 1
    buffer_store_dwordx4 v[124:127], v4, s[48:51], s79 offen sc1
    s_mov_b64 exec, -1
    s_add_u32 s56, s28, s54
    s_addc_u32 s57, s29, 0
    s_mov_b32 s59, 0
    s_mov_b32 s80, 131072
L_e1g0:
    s_load_dwordx16 s[4:19], s[56:57], 0 glc
    s_load_dwordx16 s[32:47], s[56:57], 64 glc
    s_waitcnt lgkmcnt(0)
    s_cmp_eq_u32 s5, s77
    s_cbranch_scc0 L_e1g0_retry
    s_cmp_eq_u32 s7, s77
    s_cbranch_scc0 L_e1g0_retry
    s_cmp_eq_u32 s9, s77
    s_cbranch_scc0 L_e1g0_retry
    s_cmp_eq_u32 s11, s77
    s_cbranch_scc0 L_e1g0_retry
    s_cmp_eq_u32 s13, s77
    s_cbranch_scc0 L_e1g0_retry
    s_cmp_eq_u32 s15, s77
    s_cbranch_scc0 L_e1g0_retry
    s_cmp_eq_u32 s17, s77
    s_cbranch_scc0 L_e1g0_retry
    s_cmp_eq_u32 s19, s77
    s_cbranch_scc0 L_e1g0_retry
    s_cmp_eq_u32 s33, s77
    s_cbranch_scc0 L_e1g0_retry
    s_cmp_eq_u32 s35, s77
    s_cbranch_scc0 L_e1g0_retry
    s_cmp_eq_u32 s37, s77
    s_cbranch_scc0 L_e1g0_retry
    s_cmp_eq_u32 s39, s77
    s_cbranch_scc0 L_e1g0_retry
    s_cmp_eq_u32 s41, s77
    s_cbranch_scc0 L_e1g0_retry
    s_cmp_eq_u32 s43, s77
    s_cbranch_scc0 L_e1g0_retry
    s_cmp_eq_u32 s45, s77
    s_cbranch_scc0 L_e1g0_retry
    s_cmp_eq_u32 s47, s77
    s_cbranch_scc0 L_e1g0_retry
    s_branch L_e1g0_ok
L_e1g0_retry:
    s_sleep 16
    s_add_u32 s59, s59, 1
    s_sub_u32 s80, s80, 1
    s_cmp_lg_u32 s80, 0
    s_cbranch_scc1 L_e1g0
L_e1g0_ok:
    v_mov_b32 v128, s4
    v_mov_b32 v144, s6
    v_mov_b32 v129, s8
    v_mov_b32 v145, s10
    v_mov_b32 v130, s12
    v_mov_b32 v146, s14
    v_mov_b32 v131, s16
    v_mov_b32 v147, s18
    v_mov_b32 v132, s32
    v_mov_b32 v148, s34
    v_mov_b32 v133, s36
    v_mov_b32 v149, s38
    v_mov_b32 v134, s40
    v_mov_b32 v150, s42
    v_mov_b32 v135, s44
    v_mov_b32 v151, s46
    s_mov_b32 s80, 131072
L_e1g1:
    s_load_dwordx16 s[4:19], s[56:57], 128 glc
    s_load_dwordx16 s[32:47], s[56:57], 192 glc
    s_waitcnt lgkmcnt(0)
    s_cmp_eq_u32 s5, s77
    s_cbranch_scc0 L_e1g1_retry
    s_cmp_eq_u32 s7, s77
    s_cbranch_scc0 L_e1g1_retry
    s_cmp_eq_u32 s9, s77
    s_cbranch_scc0 L_e1g1_retry
    s_cmp_eq_u32 s11, s77
    s_cbranch_scc0 L_e1g1_retry
    s_cmp_eq_u32 s13, s77
    s_cbranch_scc0 L_e1g1_retry
    s_cmp_eq_u32 s15, s77
    s_cbranch_scc0 L_e1g1_retry
    s_cmp_eq_u32 s17, s77
    s_cbranch_scc0 L_e1g1_retry
    s_cmp_eq_u32 s19, s77
    s_cbranch_scc0 L_e1g1_retry
    s_cmp_eq_u32 s33, s77
    s_cbranch_scc0 L_e1g1_retry
    s_cmp_eq_u32 s35, s77
    s_cbranch_scc0 L_e1g1_retry
    s_cmp_eq_u32 s37, s77
    s_cbranch_scc0 L_e1g1_retry
    s_cmp_eq_u32 s39, s77
    s_cbranch_scc0 L_e1g1_retry
    s_cmp_eq_u32 s41, s77
    s_cbranch_scc0 L_e1g1_retry
    s_cmp_eq_u32 s43, s77
    s_cbranch_scc0 L_e1g1_retry
    s_cmp_eq_u32 s45, s77
    s_cbranch_scc0 L_e1g1_retry
    s_cmp_eq_u32 s47, s77
    s_cbranch_scc0 L_e1g1_retry
    s_branch L_e1g1_ok
L_e1g1_retry:
    s_sleep 16
    s_add_u32 s59, s59, 1
    s_sub_u32 s80, s80, 1
    s_cmp_lg_u32 s80, 0
    s_cbranch_scc1 L_e1g1
L_e1g1_ok:
    v_mov_b32 v136, s4
    v_mov_b32 v152, s6
    v_mov_b32 v137, s8
    v_mov_b32 v153, s10
    v_mov_b32 v138, s12
    v_mov_b32 v154, s14
    v_mov_b32 v139, s16
    v_mov_b32 v155, s18
    v_mov_b32 v140, s32
    v_mov_b32 v156, s34
    v_mov_b32 v141, s36
    v_mov_b32 v157, s38
    v_mov_b32 v142, s40
    v_mov_b32 v158, s42
    v_mov_b32 v143, s44
    v_mov_b32 v159, s46
    s_cmp_le_i32 s59, 1
    s_cselect_b32 s59, 1.0, 0
    v_mov_b32 v5, s59
    ds_write_b32 v4, v5 offset:2704
    v_max3_f32 v40, v128, v129, v130
    v_max3_f32 v40, v40, v131, v132
    v_max3_f32 v40, v40, v133, v134
    v_max3_f32 v40, v40, v135, v136
    v_max3_f32 v40, v40, v137, v138
    v_max3_f32 v40, v40, v139, v140
    v_max3_f32 v40, v40, v141, v142
    v_max_f32 v40, v40, v143
    v_sub_f32 v128, v128, v40
    v_mul_f32 v128, 0.09016844005556021, v128
    v_exp_f32 v128, v128
    v_sub_f32 v129, v129, v40
    v_mul_f32 v129, 0.09016844005556021, v129
    v_exp_f32 v129, v129
    v_sub_f32 v130, v130, v40
    v_mul_f32 v130, 0.09016844005556021, v130
    v_exp_f32 v130, v130
    v_sub_f32 v131, v131, v40
    v_mul_f32 v131, 0.09016844005556021, v131
    v_exp_f32 v131, v131
    v_sub_f32 v132, v132, v40
    v_mul_f32 v132, 0.09016844005556021, v132
    v_exp_f32 v132, v132
    v_sub_f32 v133, v133, v40
    v_mul_f32 v133, 0.09016844005556021, v133
    v_exp_f32 v133, v133
    v_sub_f32 v134, v134, v40
    v_mul_f32 v134, 0.09016844005556021, v134
    v_exp_f32 v134, v134
    v_sub_f32 v135, v135, v40
    v_mul_f32 v135, 0.09016844005556021, v135
    v_exp_f32 v135, v135
    v_sub_f32 v136, v136, v40
    v_mul_f32 v136, 0.09016844005556021, v136
    v_exp_f32 v136, v136
    v_sub_f32 v137, v137, v40
    v_mul_f32 v137, 0.09016844005556021, v137
    v_exp_f32 v137, v137
    v_sub_f32 v138, v138, v40
    v_mul_f32 v138, 0.09016844005556021, v138
    v_exp_f32 v138, v138
    v_sub_f32 v139, v139, v40
    v_mul_f32 v139, 0.09016844005556021, v139
    v_exp_f32 v139, v139
    v_sub_f32 v140, v140, v40
    v_mul_f32 v140, 0.09016844005556021, v140
    v_exp_f32 v140, v140
    v_sub_f32 v141, v141, v40
    v_mul_f32 v141, 0.09016844005556021, v141
    v_exp_f32 v141, v141
    v_sub_f32 v142, v142, v40
    v_mul_f32 v142, 0.09016844005556021, v142
    v_exp_f32 v142, v142
    v_sub_f32 v143, v143, v40
    v_mul_f32 v143, 0.09016844005556021, v143
    v_exp_f32 v143, v143
    s_nop 0
    v_mul_f32 v41, v128, v144
    v_fmac_f32 v41, v129, v145
    v_fmac_f32 v41, v130, v146
    v_fmac_f32 v41, v131, v147
    v_fmac_f32 v41, v132, v148
    v_fmac_f32 v41, v133, v149
    v_fmac_f32 v41, v134, v150
    v_fmac_f32 v41, v135, v151
    v_fmac_f32 v41, v136, v152
    v_fmac_f32 v41, v137, v153
    v_fmac_f32 v41, v138, v154
    v_fmac_f32 v41, v139, v155
    v_fmac_f32 v41, v140, v156
    v_fmac_f32 v41, v141, v157
    v_fmac_f32 v41, v142, v158
    v_fmac_f32 v41, v143, v159
L_e1skip:
    v_rcp_f32 v6, v41
    v_sub_f32 v120, v112, v40
    v_mul_f32 v120, 0.09016844005556021, v120
    v_exp_f32 v120, v120
    v_sub_f32 v121, v114, v40
    v_mul_f32 v121, 0.09016844005556021, v121
    v_exp_f32 v121, v121
    v_sub_f32 v122, v116, v40
    v_mul_f32 v122, 0.09016844005556021, v122
    v_exp_f32 v122, v122
    v_sub_f32 v123, v118, v40
    v_mul_f32 v123, 0.09016844005556021, v123
    v_exp_f32 v123, v123
    v_fma_f32 v7, -v41, v6, 1.0
    v_fmac_f32 v6, v7, v6
    v_mul_f32 v120, v120, v6
    v_mul_f32 v121, v121, v6
    v_mul_f32 v122, v122, v6
    v_mul_f32 v123, v123, v6
    s_mov_b64 exec, 1
    ds_write_b128 v4, v[120:123] offset:2688
    s_mov_b64 exec, -1
    s_waitcnt lgkmcnt(0)
L_t_noe1:
    v_lshrrev_b32 v32, 4, v3
    v_lshlrev_b32 v32, 11, v32
    v_and_b32 v4, 15, v3
    v_lshl_add_u32 v32, v4, 3, v32
    s_lshl_b32 s54, s30, 15
    s_lshl_b32 s79, s31, 7
    s_add_u32 s96, s54, s79
    s_add_u32 s96, s96, 2097152
    s_lshl_b32 s79, s31, 11
    s_add_u32 s97, s54, s79
    s_add_u32 s97, s97, 2097152
    v_lshlrev_b32 v33, 5, v1
    v_lshlrev_b32 v34, 2, v3
    s_and_b32 s54, s2, 7
    s_lshl_b32 s54, s54, 11
    s_and_b32 s79, s53, 31
    s_lshl_b32 s79, s79, 11
    s_add_u32 s99, s79, 196608
    s_and_b32 s54, s31, 7
    s_lshl_b32 s54, s54, 11
    s_add_u32 s98, s54, 65536
    v_and_b32 v4, 3, v1
    v_lshlrev_b32 v4, 2, v4
    v_lshrrev_b32 v5, 4, v1
    v_add_u32 v4, v4, v5
    v_lshlrev_b32 v47, 1, v4
    v_lshlrev_b32 v35, 4, v1
    v_mov_b32 v5, 0x7fffffff
    v_cndmask_b32 v36, v5, v35, s[88:89]
    s_lshl_b32 s54, s76, 11
    v_add_u32 v37, s54, v35
    v_mov_b32 v38, v35
    v_lshlrev_b32 v4, 3, v1
    s_lshl_b32 s54, s76, 10
    v_add_u32 v39, s54, v4
    v_lshrrev_b32 v4, 3, v1
    v_lshlrev_b32 v4, 5, v4
    s_lshl_b32 s79, s76, 8
    s_add_u32 s54, s54, s79
    v_add_u32 v44, s54, v4
    v_and_b32 v46, 7, v1
    v_lshlrev_b32 v46, 2, v46
    s_lshl_b32 s54, s76, 5
    v_add_u32 v45, s54, v46
    v_lshrrev_b32 v4, 3, v1
    v_lshlrev_b32 v92, 6, v4
    v_and_b32 v5, 7, v1
    v_lshl_add_u32 v93, v5, 4, v92
    v_mul_u32_u24 v5, 12, v5
    v_add_u32 v94, v44, v5
    s_load_dwordx4 s[16:19], s[0:1], 48
    s_load_dwordx2 s[8:9], s[0:1], 64
    s_waitcnt lgkmcnt(0)
    s_mul_i32 s54, s53, 7168
    s_add_u32 s32, s8, s54
    s_addc_u32 s33, s9, 0
    s_sub_u32 s34, 1605632, s54
    s_mov_b32 s35, 0x20000
    s_lshl_b32 s54, s53, 4
    s_add_u32 s36, s16, s54
    s_addc_u32 s37, s17, 0
    s_sub_u32 s38, 1605632, s54
    s_mov_b32 s39, 0x20000
    s_add_u32 s44, s18, s54
    s_addc_u32 s45, s19, 0
    s_sub_u32 s46, 3584, s54
    s_mov_b32 s47, 0x20000
    s_mul_i32 s79, s76, 120
    v_add_u32 v4, s79, v1
    s_movk_i32 s79, 3584
    v_mul_lo_u32 v95, v4, s79
    v_add_u32 v96, 229376, v95
    v_and_b32 v4, 7, v1
    v_lshlrev_b32 v97, 1, v4
    s_and_b32 s54, s2, 7
    s_lshl_b32 s54, s54, 11
    s_lshl_b32 s79, s76, 9
    s_add_u32 s54, s54, s79
    s_add_u32 s4, s54, 131072
    s_and_b32 s54, s2, 7
    s_lshl_b32 s54, s54, 11
    s_and_b32 s79, s76, 1
    s_lshl_b32 s79, s79, 10
    s_add_u32 s54, s54, s79
    s_lshr_b32 s79, s76, 1
    s_mul_i32 s79, s79, 16384
    s_add_u32 s54, s54, s79
    s_add_u32 s5, s54, 131072
    s_mov_b32 s40, s24
    s_mov_b32 s41, s25
    s_mov_b32 s42, 896
    s_mov_b32 s43, 0x20000
    s_barrier
    ds_read_b32 v112, v34 offset:3072
    ds_read_b32 v113, v34 offset:4096
    ds_read_b32 v114, v34 offset:5120
    ds_read_b32 v115, v34 offset:6144
    v_mov_b32 v117, s77
    s_waitcnt lgkmcnt(1)
    v_add_f32 v112, v112, v113
    s_waitcnt lgkmcnt(0)
    v_add_f32 v114, v114, v115
    v_add_f32 v116, v112, v114
    buffer_store_dwordx2 v[116:117], v32, s[48:51], s96 offen
    s_add_u32 s96, s96, 524288
    buffer_store_dwordx2 v[116:117], v32, s[48:51], s96 offen sc1
    s_cmp_eq_u32 s76, 2
    s_cbranch_scc0 L_t_noinit
    v_lshlrev_b32 v4, 4, v1
    s_mov_b32 s54, 1024
    s_mov_b32 s84, -1
    s_mov_b32 s85, 0xff
    s_mov_b32 s80, 131072
    s_mov_b64 exec, s[84:85]
L_poll_init_2:
    buffer_load_dwordx4 v[120:123], v4, s[48:51], s54 offen sc1
    s_waitcnt vmcnt(0)
    v_cmp_eq_u32 vcc, s77, v121
    v_cmp_eq_u32 s[82:83], s77, v123
    s_and_b64 vcc, vcc, s[82:83]
    s_andn2_b64 exec, exec, vcc
    s_cbranch_scc0 L_poll_init_2_ok
    s_sleep 1
    s_sub_u32 s80, s80, 1
    s_cmp_lg_u32 s80, 0
    s_cbranch_scc1 L_poll_init_2
L_poll_init_2_ok:
    s_mov_b64 exec, -1
L_t_noinit:
    s_cmp_eq_u32 s76, 0
    s_cbranch_scc0 L_t_barC
    s_mov_b32 s79, s97
    s_mov_b32 s80, 131072
L_poll_e2_3:
    buffer_load_dwordx4 v[120:123], v33, s[48:51], s79 offen sc1
    buffer_load_dwordx4 v[124:127], v33, s[48:51], s79 offen offset:16 sc1
    s_waitcnt vmcnt(0)
    v_cmp_eq_u32 vcc, s77, v121
    v_cmp_eq_u32 s[82:83], s77, v123
    s_and_b64 vcc, vcc, s[82:83]
    v_cmp_eq_u32 s[82:83], s77, v125
    s_and_b64 vcc, vcc, s[82:83]
    v_cmp_eq_u32 s[82:83], s77, v127
    s_and_b64 vcc, vcc, s[82:83]
    s_andn2_b64 exec, exec, vcc
    s_cbranch_scc0 L_poll_e2_3_ok
    s_sub_u32 s80, s80, 1
    s_and_b32 s79, s80, 63
    s_cmp_eq_u32 s79, 0
    s_cselect_b32 s79, 524288, 0
    s_add_u32 s79, s79, s97
    s_cmp_lg_u32 s80, 0
    s_cbranch_scc1 L_poll_e2_3
L_poll_e2_3_ok:
    s_mov_b64 exec, -1
    v_permlane32_swap_b32 v120, v124
    v_permlane32_swap_b32 v122, v126
    v_add_f32 v120, v120, v124
    v_add_f32 v122, v122, v126
    s_nop 1
    v_permlane16_swap_b32 v120, v122
    v_add_f32 v120, v120, v122
    s_nop 1
    v_add_f32_dpp v120, v120, v120 row_ror:8 row_mask:0xf bank_mask:0xf
    s_nop 1
    v_add_f32_dpp v120, v120, v120 row_ror:4 row_mask:0xf bank_mask:0xf
    v_cvt_pk_bf16_f32 v120, v120, v120
    ds_write_b16 v47, v120 offset:2560
    s_waitcnt lgkmcnt(0)
L_t_barC:
    v_mov_b32 v4, 0
    v_mov_b32 v120, v64
    v_mov_b32 v121, v65
    v_mov_b32 v122, 0
    v_mov_b32 v123, 0
    s_barrier
    ds_read_b128 v[112:115], v4 offset:2560
    ds_read_b128 v[116:119], v4 offset:2576
    s_waitcnt lgkmcnt(1)
    v_dot2c_f32_bf16 v120, v16, v112
    v_dot2c_f32_bf16 v121, v24, v112
    v_dot2c_f32_bf16 v120, v17, v113
    v_dot2c_f32_bf16 v121, v25, v113
    v_dot2c_f32_bf16 v120, v18, v114
    v_dot2c_f32_bf16 v121, v26, v114
    v_dot2c_f32_bf16 v120, v19, v115
    v_dot2c_f32_bf16 v121, v27, v115
    s_waitcnt lgkmcnt(0)
    v_dot2c_f32_bf16 v122, v20, v116
    v_dot2c_f32_bf16 v123, v28, v116
    v_dot2c_f32_bf16 v122, v21, v117
    v_dot2c_f32_bf16 v123, v29, v117
    v_dot2c_f32_bf16 v122, v22, v118
    v_dot2c_f32_bf16 v123, v30, v118
    v_dot2c_f32_bf16 v122, v23, v119
    v_dot2c_f32_bf16 v123, v31, v119
    s_nop 2
    v_pk_add_f32 v[120:121], v[120:121], v[122:123]
    buffer_atomic_add_f32 v120, v34, s[48:51], s98 offen
    s_mov_b64 exec, s[86:87]
    buffer_atomic_add_f32 v121, v34, s[48:51], s98 offen offset:1024
    s_mov_b64 exec, -1
    s_cmp_lt_u32 s2, 224
    s_cbranch_scc0 L_t_done
    s_cmp_eq_u32 s58, 1
    s_cbranch_scc0 L_t_lateskip
    s_add_u32 m0, s55, 4096
    s_mov_b32 s79, 0
    buffer_load_dwordx4 v2, s[32:35], s79 offen nt lds
    s_add_u32 m0, s55, 5120
    s_mov_b32 s79, 480
    buffer_load_dwordx4 v2, s[32:35], s79 offen nt lds
    buffer_load_ushort v66, v97, s[44:47], 0 offen nt
    s_add_u32 m0, s55, 6144
    s_mov_b32 s79, 0
    buffer_load_dwordx4 v95, s[36:39], s79 offen nt lds
    s_add_u32 m0, s55, 7168
    s_mov_b32 s79, 0
    buffer_load_dwordx4 v96, s[36:39], s79 offen nt lds
    v_and_b32 v5, 15, v1
    v_lshrrev_b32 v6, 4, v1
    v_mul_u32_u24 v6, 15, v6
    v_add_u32 v6, v6, v5
    s_and_b32 s54, s76, 1
    s_lshl_b32 s54, s54, 3
    s_add_u32 s54, s54, s55
    v_lshl_add_u32 v4, v6, 1, s54
    v_cmp_gt_u32 s[82:83], 15, v5
    s_mul_i32 s54, s76, 60
    v_add_u32 v7, s54, v6
    s_movk_i32 s79, 208
    v_cmp_gt_u32 s[84:85], s79, v7
    s_and_b64 s[84:85], s[84:85], s[82:83]
    s_waitcnt vmcnt(2)
    v_lshlrev_b32 v66, 16, v66
    ds_read_u16 v112, v4 offset:4096
    ds_read_u16 v113, v4 offset:4224
    ds_read_u16 v114, v4 offset:4352
    ds_read_u16 v115, v4 offset:4480
    ds_read_u16 v116, v4 offset:4608
    ds_read_u16 v117, v4 offset:4736
    ds_read_u16 v118, v4 offset:4864
    ds_read_u16 v119, v4 offset:4992
    s_waitcnt lgkmcnt(0)
    v_lshl_or_b32 v56, v113, 16, v112
    v_lshl_or_b32 v57, v115, 16, v114
    v_lshl_or_b32 v58, v117, 16, v116
    v_lshl_or_b32 v59, v119, 16, v118
    ds_read_u16 v112, v4 offset:5120
    ds_read_u16 v113, v4 offset:5248
    ds_read_u16 v114, v4 offset:5376
    ds_read_u16 v115, v4 offset:5504
    ds_read_u16 v116, v4 offset:5632
    ds_read_u16 v117, v4 offset:5760
    ds_read_u16 v118, v4 offset:5888
    ds_read_u16 v119, v4 offset:6016
    s_waitcnt lgkmcnt(0)
    v_lshl_or_b32 v60, v113, 16, v112
    v_lshl_or_b32 v61, v115, 16, v114
    v_lshl_or_b32 v62, v117, 16, v116
    v_lshl_or_b32 v63, v119, 16, v118
    v_cndmask_b32 v56, 0, v56, s[82:83]
    v_cndmask_b32 v60, 0, v60, s[84:85]
    v_cndmask_b32 v57, 0, v57, s[82:83]
    v_cndmask_b32 v61, 0, v61, s[84:85]
    v_cndmask_b32 v58, 0, v58, s[82:83]
    v_cndmask_b32 v62, 0, v62, s[84:85]
    v_cndmask_b32 v59, 0, v59, s[82:83]
    v_cndmask_b32 v63, 0, v63, s[84:85]
    v_lshrrev_b32 v5, 3, v1
    v_mul_u32_u24 v5, 240, v5
    v_and_b32 v6, 7, v1
    v_lshl_add_u32 v5, v6, 1, v5
    v_add_u32 v5, s55, v5
    s_waitcnt vmcnt(0)
    ds_read_u16 v112, v5 offset:6144
    ds_read_u16 v113, v5 offset:6160
    ds_read_u16 v114, v5 offset:6176
    ds_read_u16 v115, v5 offset:6192
    ds_read_u16 v116, v5 offset:6208
    ds_read_u16 v117, v5 offset:6224
    ds_read_u16 v118, v5 offset:6240
    ds_read_u16 v119, v5 offset:6256
    ds_read_u16 v120, v5 offset:6272
    ds_read_u16 v121, v5 offset:6288
    ds_read_u16 v122, v5 offset:6304
    ds_read_u16 v123, v5 offset:6320
    ds_read_u16 v124, v5 offset:6336
    ds_read_u16 v125, v5 offset:6352
    ds_read_u16 v126, v5 offset:6368
    v_mov_b32 v127, 0
    s_waitcnt lgkmcnt(0)
    v_lshl_or_b32 v48, v113, 16, v112
    v_lshl_or_b32 v49, v115, 16, v114
    v_lshl_or_b32 v50, v117, 16, v116
    v_lshl_or_b32 v51, v119, 16, v118
    v_lshl_or_b32 v52, v121, 16, v120
    v_lshl_or_b32 v53, v123, 16, v122
    v_lshl_or_b32 v54, v125, 16, v124
    v_lshl_or_b32 v55, v127, 16, v126
L_t_lateskip:
    s_cmp_lt_u32 s2, 8
    s_cbranch_scc0 L_t_notleader
    s_lshl_b32 s54, s76, 12
    s_add_u32 s54, s54, 65536
    s_mov_b32 s81, 0x42000000
    s_mov_b32 s80, 131072
L_g_acc:
    buffer_load_dwordx4 v[160:163], v35, s[48:51], s54 offen sc1
    buffer_load_dwordx4 v[164:167], v36, s[48:51], s54 offen offset:1024 sc1
    buffer_load_dwordx4 v[168:171], v35, s[48:51], s54 offen offset:2048 sc1
    buffer_load_dwordx4 v[172:175], v36, s[48:51], s54 offen offset:3072 sc1
    s_waitcnt vmcnt(0)
    v_mov_b32_dpp v144, v163 quad_perm:[3,3,3,3] row_mask:0xf bank_mask:0xf
    v_mov_b32_dpp v145, v167 quad_perm:[3,3,3,3] row_mask:0xf bank_mask:0xf
    v_mov_b32_dpp v146, v171 quad_perm:[3,3,3,3] row_mask:0xf bank_mask:0xf
    v_mov_b32_dpp v147, v175 quad_perm:[3,3,3,3] row_mask:0xf bank_mask:0xf
    v_cmp_eq_u32 vcc, s81, v144
    v_cmp_eq_u32 s[82:83], s81, v146
    s_and_b64 vcc, vcc, s[82:83]
    v_cmp_eq_u32 s[82:83], s81, v145
    v_cmp_eq_u32 s[84:85], s81, v147
    s_and_b64 s[82:83], s[82:83], s[84:85]
    s_orn2_b64 s[82:83], s[82:83], s[88:89]
    s_and_b64 vcc, vcc, s[82:83]
    s_cmp_eq_u64 vcc, -1
    s_cbranch_scc1 L_g_acc_okA
    s_sub_u32 s80, s80, 1
    s_cmp_lg_u32 s80, 0
    s_cbranch_scc1 L_g_acc
L_g_acc_okA:
    v_pk_add_f32 v[112:113], v[160:161], v[168:169]
    v_pk_add_f32 v[114:115], v[162:163], v[170:171]
    v_pk_add_f32 v[116:117], v[164:165], v[172:173]
    v_pk_add_f32 v[118:119], v[166:167], v[174:175]
    ds_write_b128 v37, v[112:115] offset:7168
    ds_write_b128 v37, v[116:119] offset:8192
    s_waitcnt lgkmcnt(0)
    s_barrier
    ds_read_b128 v[112:115], v38 offset:7168
    ds_read_b128 v[116:119], v38 offset:8192
    ds_read_b128 v[120:123], v38 offset:9216
    ds_read_b128 v[124:127], v38 offset:10240
    ds_read_b128 v[128:131], v38 offset:11264
    ds_read_b128 v[132:135], v38 offset:12288
    ds_read_b128 v[136:139], v38 offset:13312
    ds_read_b128 v[140:143], v38 offset:14336
    s_waitcnt lgkmcnt(4)
    v_pk_add_f32 v[112:113], v[112:113], v[120:121]
    v_pk_add_f32 v[114:115], v[114:115], v[122:123]
    v_pk_add_f32 v[116:117], v[116:117], v[124:125]
    v_pk_add_f32 v[118:119], v[118:119], v[126:127]
    s_waitcnt lgkmcnt(0)
    v_pk_add_f32 v[128:129], v[128:129], v[136:137]
    v_pk_add_f32 v[130:131], v[130:131], v[138:139]
    v_pk_add_f32 v[132:133], v[132:133], v[140:141]
    v_pk_add_f32 v[134:135], v[134:135], v[142:143]
    v_pk_add_f32 v[112:113], v[112:113], v[128:129]
    v_pk_add_f32 v[114:115], v[114:115], v[130:131]
    v_pk_add_f32 v[116:117], v[116:117], v[132:133]
    v_pk_add_f32 v[118:119], v[118:119], v[134:135]
    v_cvt_pk_bf16_f32 v120, v112, v113
    v_cvt_pk_bf16_f32 v121, v114, v115
    v_cvt_pk_bf16_f32 v122, v116, v117
    v_cvt_pk_bf16_f32 v123, v118, v119
    v_lshlrev_b32 v112, 16, v120
    v_and_b32 v113, 0xffff0000, v120
    v_lshlrev_b32 v114, 16, v121
    v_and_b32 v115, 0xffff0000, v121
    v_lshlrev_b32 v116, 16, v122
    v_and_b32 v117, 0xffff0000, v122
    v_lshlrev_b32 v118, 16, v123
    v_and_b32 v119, 0xffff0000, v123
    v_pk_add_f32 v[112:113], v[112:113], v[68:69]
    v_pk_add_f32 v[114:115], v[114:115], v[70:71]
    v_pk_add_f32 v[116:117], v[116:117], v[72:73]
    v_pk_add_f32 v[118:119], v[118:119], v[74:75]
    v_cvt_pk_bf16_f32 v120, v112, v113
    v_cvt_pk_bf16_f32 v121, v114, v115
    v_cvt_pk_bf16_f32 v122, v116, v117
    v_cvt_pk_bf16_f32 v123, v118, v119
    v_lshlrev_b32 v84, 16, v120
    v_and_b32 v85, 0xffff0000, v120
    v_lshlrev_b32 v86, 16, v121
    v_and_b32 v87, 0xffff0000, v121
    v_lshlrev_b32 v88, 16, v122
    v_and_b32 v89, 0xffff0000, v122
    v_lshlrev_b32 v90, 16, v123
    v_and_b32 v91, 0xffff0000, v123
    ds_write_b128 v38, v[84:87] offset:20224
    ds_write_b128 v38, v[88:91] offset:21248
    v_readfirstlane_b32 s100, v84
    s_nop 1
    v_pk_add_f32 v[120:121], v[84:85], s[100:101] op_sel_hi:[1,0] neg_lo:[0,1] neg_hi:[0,1]
    v_pk_add_f32 v[122:123], v[86:87], s[100:101] op_sel_hi:[1,0] neg_lo:[0,1] neg_hi:[0,1]
    v_pk_add_f32 v[124:125], v[88:89], s[100:101] op_sel_hi:[1,0] neg_lo:[0,1] neg_hi:[0,1]
    v_pk_add_f32 v[126:127], v[90:91], s[100:101] op_sel_hi:[1,0] neg_lo:[0,1] neg_hi:[0,1]
    v_cndmask_b32 v123, 0, v123, s[90:91]
    v_cndmask_b32 v124, 0, v124, s[88:89]
    v_cndmask_b32 v125, 0, v125, s[92:93]
    v_cndmask_b32 v126, 0, v126, s[92:93]
    v_cndmask_b32 v127, 0, v127, s[94:95]
    v_pk_add_f32 v[128:129], v[120:121], v[122:123]
    v_pk_mul_f32 v[132:133], v[120:121], v[120:121]
    v_pk_add_f32 v[130:131], v[124:125], v[126:127]
    v_pk_fma_f32 v[132:133], v[122:123], v[122:123], v[132:133]
    v_pk_add_f32 v[128:129], v[128:129], v[130:131]
    v_pk_fma_f32 v[132:133], v[124:125], v[124:125], v[132:133]
    v_add_f32 v40, v128, v129
    v_pk_fma_f32 v[132:133], v[126:127], v[126:127], v[132:133]
    v_add_f32 v41, v132, v133
    s_nop 0
    v_add_f32_dpp v40, v40, v40 row_ror:8 row_mask:0xf bank_mask:0xf
    v_add_f32_dpp v41, v41, v41 row_ror:8 row_mask:0xf bank_mask:0xf
    s_nop 0
    v_add_f32_dpp v40, v40, v40 row_ror:4 row_mask:0xf bank_mask:0xf
    v_add_f32_dpp v41, v41, v41 row_ror:4 row_mask:0xf bank_mask:0xf
    s_nop 0
    v_add_f32_dpp v40, v40, v40 row_ror:2 row_mask:0xf bank_mask:0xf
    v_add_f32_dpp v41, v41, v41 row_ror:2 row_mask:0xf bank_mask:0xf
    s_nop 0
    v_add_f32_dpp v40, v40, v40 row_ror:1 row_mask:0xf bank_mask:0xf
    v_add_f32_dpp v41, v41, v41 row_ror:1 row_mask:0xf bank_mask:0xf
    v_mov_b32 v6, v40
    v_mov_b32 v7, v41
    s_nop 0
    v_permlane16_swap_b32 v40, v6
    v_permlane16_swap_b32 v41, v7
    v_add_f32 v40, v40, v6
    v_add_f32 v41, v41, v7
    v_mov_b32 v6, v40
    v_mov_b32 v7, v41
    s_nop 0
    v_permlane32_swap_b32 v40, v6
    v_permlane32_swap_b32 v41, v7
    v_add_f32 v40, v40, v6
    v_add_f32 v41, v41, v7
    v_mul_f32 v40, 0.002232142857142857, v40
    v_mul_f32 v41, 0.002232142857142857, v41
    v_fma_f32 v41, -v40, v40, v41
    v_add_f32 v40, s100, v40
    v_cvt_pk_bf16_f32 v41, v41, v41
    v_lshlrev_b32 v41, 16, v41
    v_add_f32 v41, 1e-05, v41
    v_cvt_pk_bf16_f32 v41, v41, v41
    v_lshlrev_b32 v41, 16, v41
    v_sqrt_f32 v41, v41
    v_cvt_pk_bf16_f32 v40, v40, v40
    v_cvt_pk_bf16_f32 v41, v41, v41
    v_lshlrev_b32 v40, 16, v40
    v_lshlrev_b32 v41, 16, v41
    v_rcp_f32 v42, v41
    v_pk_add_f32 v[112:113], v[84:85], v[40:41] op_sel_hi:[1,0] neg_lo:[0,1] neg_hi:[0,1]
    v_pk_add_f32 v[114:115], v[86:87], v[40:41] op_sel_hi:[1,0] neg_lo:[0,1] neg_hi:[0,1]
    v_pk_add_f32 v[116:117], v[88:89], v[40:41] op_sel_hi:[1,0] neg_lo:[0,1] neg_hi:[0,1]
    v_pk_add_f32 v[118:119], v[90:91], v[40:41] op_sel_hi:[1,0] neg_lo:[0,1] neg_hi:[0,1]
    v_cvt_pk_bf16_f32 v120, v112, v113
    v_cvt_pk_bf16_f32 v121, v114, v115
    v_cvt_pk_bf16_f32 v122, v116, v117
    v_cvt_pk_bf16_f32 v123, v118, v119
    v_lshlrev_b32 v112, 16, v120
    v_and_b32 v113, 0xffff0000, v120
    v_lshlrev_b32 v114, 16, v121
    v_and_b32 v115, 0xffff0000, v121
    v_lshlrev_b32 v116, 16, v122
    v_and_b32 v117, 0xffff0000, v122
    v_lshlrev_b32 v118, 16, v123
    v_and_b32 v119, 0xffff0000, v123
    v_pk_mul_f32 v[112:113], v[112:113], v[42:43] op_sel_hi:[1,0]
    v_pk_mul_f32 v[114:115], v[114:115], v[42:43] op_sel_hi:[1,0]
    v_pk_mul_f32 v[116:117], v[116:117], v[42:43] op_sel_hi:[1,0]
    v_pk_mul_f32 v[118:119], v[118:119], v[42:43] op_sel_hi:[1,0]
    v_cvt_pk_bf16_f32 v120, v112, v113
    v_cvt_pk_bf16_f32 v121, v114, v115
    v_cvt_pk_bf16_f32 v122, v116, v117
    v_cvt_pk_bf16_f32 v123, v118, v119
    s_and_b32 s54, s76, 1
    s_cmp_eq_u32 s54, 0
    s_cbranch_scc1 L_pubA
    v_mov_b32 v120, v122
    v_mov_b32 v121, v123
L_pubA:
    v_mov_b32 v122, v121
    v_mov_b32 v121, s77
    v_mov_b32 v123, s77
    s_cmp_lt_u32 s76, 2
    s_cbranch_scc0 L_pubB
    buffer_store_dwordx4 v[120:123], v35, s[48:51], s5 offen
    s_branch L_pubdone
L_pubB:
    buffer_store_dwordx4 v[120:123], v35, s[48:51], s5 offen sc1
L_pubdone:
L_t_notleader:
    s_mov_b32 s79, s4
    v_mov_b32 v112, 0
    v_mov_b32 v113, 0
    s_mov_b32 s80, 131072
L_poll_hn_5:
    buffer_load_dwordx4 v[128:131], v92, s[48:51], s79 offen offset:0 sc1
    buffer_load_dwordx4 v[132:135], v92, s[48:51], s79 offen offset:16 sc1
    buffer_load_dwordx4 v[136:139], v92, s[48:51], s79 offen offset:32 sc1
    buffer_load_dwordx4 v[140:143], v92, s[48:51], s79 offen offset:48 sc1
    s_waitcnt vmcnt(0)
    v_cmp_eq_u32 vcc, s77, v129
    v_cmp_eq_u32 s[82:83], s77, v131
    s_and_b64 vcc, vcc, s[82:83]
    v_cmp_eq_u32 s[82:83], s77, v133
    s_and_b64 vcc, vcc, s[82:83]
    v_cmp_eq_u32 s[82:83], s77, v135
    s_and_b64 vcc, vcc, s[82:83]
    v_cmp_eq_u32 s[82:83], s77, v137
    s_and_b64 vcc, vcc, s[82:83]
    v_cmp_eq_u32 s[82:83], s77, v139
    s_and_b64 vcc, vcc, s[82:83]
    v_cmp_eq_u32 s[82:83], s77, v141
    s_and_b64 vcc, vcc, s[82:83]
    v_cmp_eq_u32 s[82:83], s77, v143
    s_and_b64 vcc, vcc, s[82:83]
    s_andn2_b64 exec, exec, vcc
    s_cbranch_scc0 L_poll_hn_5_ok
    s_sleep 1
    s_sub_u32 s80, s80, 1
    s_and_b32 s79, s80, 63
    s_cmp_eq_u32 s79, 0
    s_cselect_b32 s79, 16384, 0
    s_add_u32 s79, s79, s4
    s_cmp_lg_u32 s80, 0
    s_cbranch_scc1 L_poll_hn_5
L_poll_hn_5_ok:
    s_mov_b64 exec, -1
    v_dot2c_f32_bf16 v112, v48, v128
    v_dot2c_f32_bf16 v113, v49, v130
    v_dot2c_f32_bf16 v112, v50, v132
    v_dot2c_f32_bf16 v113, v51, v134
    v_dot2c_f32_bf16 v112, v52, v136
    v_dot2c_f32_bf16 v113, v53, v138
    v_dot2c_f32_bf16 v112, v54, v140
    v_dot2c_f32_bf16 v113, v55, v142
    s_nop 2
    v_add_f32 v112, v112, v113
    s_nop 1
    v_add_f32_dpp v112, v112, v112 row_ror:8 row_mask:0xf bank_mask:0xf
    v_mov_b32 v113, v112
    s_nop 1
    v_permlane16_swap_b32 v112, v113
    v_add_f32 v112, v112, v113
    v_mov_b32 v113, v112
    s_nop 1
    v_permlane32_swap_b32 v112, v113
    v_add_f32 v112, v112, v113
    ds_write_b32 v45, v112 offset:19456
    s_waitcnt lgkmcnt(0)
    s_barrier
    ds_read_b32 v112, v46 offset:19456
    ds_read_b32 v113, v46 offset:19488
    ds_read_b32 v114, v46 offset:19520
    ds_read_b32 v115, v46 offset:19552
    s_waitcnt lgkmcnt(0)
    v_pk_add_f32 v[112:113], v[112:113], v[114:115]
    v_add_f32 v112, v112, v113
    v_cvt_pk_bf16_f32 v112, v112, v112
    v_lshlrev_b32 v112, 16, v112
    v_add_f32 v112, v112, v66
    v_cvt_pk_bf16_f32 v112, v112, v112
    v_lshlrev_b32 v112, 16, v112
    v_max_f32 v112, 0, v112
    v_mul_f32 v112, v112, v112
    v_mov_b32 v116, v64
    v_mov_b32 v117, v65
    v_mov_b32_dpp v113, v112 quad_perm:[1,0,3,2] row_mask:0xf bank_mask:0xf
    v_cvt_pk_bf16_f32 v112, v112, v113
    s_nop 0
    v_readlane_b32 s82, v112, 0
    v_readlane_b32 s83, v112, 2
    v_readlane_b32 s84, v112, 4
    v_readlane_b32 s85, v112, 6
    s_nop 1
    v_dot2c_f32_bf16 v116, s82, v56
    v_dot2c_f32_bf16 v117, s82, v60
    v_dot2c_f32_bf16 v116, s83, v57
    v_dot2c_f32_bf16 v117, s83, v61
    v_dot2c_f32_bf16 v116, s84, v58
    v_dot2c_f32_bf16 v117, s84, v62
    v_dot2c_f32_bf16 v116, s85, v59
    v_dot2c_f32_bf16 v117, s85, v63
    s_nop 2
    buffer_atomic_add_f32 v116, v34, s[48:51], s99 offen
    s_mov_b64 exec, s[86:87]
    buffer_atomic_add_f32 v117, v34, s[48:51], s99 offen offset:1024
    s_mov_b64 exec, -1
    s_cmp_lt_u32 s2, 8
    s_cbranch_scc0 L_t_done
    s_cmp_lt_u32 s22, 30
    s_cbranch_scc0 L_t_done
    ds_read_b32 v132, v77 offset:20224
    s_lshl_b32 s54, s22, 6
    s_add_u32 s54, s54, 196608
    s_add_u32 s79, s54, 32768
    s_mov_b32 s81, 0x40e00000
    s_mov_b32 s80, 131072
L_fin:
    buffer_load_dwordx4 v[192:195], v79, s[48:51], s54 offen sc1
    buffer_load_dwordx4 v[196:199], v79, s[48:51], s79 offen sc1
    s_waitcnt vmcnt(0)
    v_mov_b32_dpp v120, v195 quad_perm:[3,3,3,3] row_mask:0xf bank_mask:0xf
    v_mov_b32_dpp v121, v199 quad_perm:[3,3,3,3] row_mask:0xf bank_mask:0xf
    v_cmp_eq_u32 vcc, s81, v120
    v_cmp_eq_u32 s[82:83], s81, v121
    s_and_b64 vcc, vcc, s[82:83]
    s_cmp_eq_u64 vcc, -1
    s_cbranch_scc1 L_fin_okA
    s_sub_u32 s80, s80, 1
    s_cmp_lg_u32 s80, 0
    s_cbranch_scc1 L_fin
L_fin_okA:
    v_pk_add_f32 v[112:113], v[192:193], v[196:197]
    v_pk_add_f32 v[114:115], v[194:195], v[198:199]
    s_nop 1
    v_permlane32_swap_b32 v112, v114
    v_permlane32_swap_b32 v113, v115
    v_pk_add_f32 v[112:113], v[112:113], v[114:115]
    s_nop 1
    v_permlane16_swap_b32 v112, v113
    v_add_f32 v112, v112, v113
    s_nop 1
    v_add_f32_dpp v112, v112, v112 row_ror:8 row_mask:0xf bank_mask:0xf
    s_nop 1
    v_add_f32_dpp v112, v112, v112 row_ror:4 row_mask:0xf bank_mask:0xf
    v_cvt_pk_bf16_f32 v112, v112, v112
    v_lshlrev_b32 v112, 16, v112
    v_add_f32 v112, v112, v78
    v_cvt_pk_bf16_f32 v112, v112, v112
    v_lshlrev_b32 v112, 16, v112
    s_waitcnt lgkmcnt(0)
    v_add_f32 v112, v112, v132
    v_cvt_pk_bf16_f32 v112, v112, v112
    s_mov_b64 exec, s[20:21]
    buffer_store_short v112, v76, s[40:43], 0 offen
    s_mov_b64 exec, -1
    s_cmp_eq_u32 s2, 0
    s_cbranch_scc0 L_t_done
    s_cmp_eq_u32 s76, 0
    s_cbranch_scc0 L_t_done
    s_add_u32 s54, s78, 1
    v_mov_b32 v5, s54
    v_mov_b32 v4, 0
    s_mov_b64 exec, 1
    buffer_store_dword v5, v4, s[48:51], 0 offen sc1
    s_mov_b64 exec, -1
L_t_done:
L_end:
    s_endpgm
.section .rodata,"a"
.p2align 6
.amdhsa_kernel sequential_preLN__mha_block_cached__dense_activation_squared_relu__decode_kernel
  .amdhsa_next_free_vgpr 248
  .amdhsa_next_free_sgpr 102
  .amdhsa_accum_offset 248
  .amdhsa_group_segment_fixed_size 0
  .amdhsa_kernarg_size 104
  .amdhsa_user_sgpr_count 2
  .amdhsa_user_sgpr_kernarg_segment_ptr 1
  .amdhsa_system_sgpr_workgroup_id_x 1
  .amdhsa_float_denorm_mode_32 3
.end_amdhsa_kernel
```
